```python
import torch

def _softmax(x, axis=-1):
    return torch.softmax(x, dim=axis)
def _gelu(x):
    return torch.nn.functional.gelu(x, approximate="tanh")
def _silu(x):
    return torch.nn.functional.silu(x)
def _sigmoid(x):
    return torch.sigmoid(x)
def _layernorm(x, axis=-1, eps=1e-5):
    m = x.mean(dim=axis, keepdim=True)
    v = x.var(dim=axis, keepdim=True, unbiased=False)
    return (x - m) / torch.sqrt(v + eps)
def _scatter_add(tgt, idx, src, axis=0):
    return tgt.clone().index_add_(axis, idx, src)
def _segment_sum(src, seg, n):
    out = torch.zeros((n,) + src.shape[1:], dtype=src.dtype)
    return out.index_add_(0, seg, src)
def _pad(x, pw):
    flat = tuple(v for pair in reversed(pw) for v in pair)
    return torch.nn.functional.pad(x, flat)

kernel_name = 'standalone__instancenorm__prompt'

def setup_inputs():

    _w = (lambda a: (lambda t: t.to(torch.bfloat16) if t.is_floating_point() else t)(torch.as_tensor(a)))
    B, C, H, W = 1, 448, 4096, 16
    return {
        "x": _w(abs((lambda *s: torch.randn(*s, dtype=torch.bfloat16) * 0.05)(B, C, H, W))),
        "g": _w((lambda *s: torch.randn(*s, dtype=torch.bfloat16) * 0.05)(C) + 1.0),
        "b": _w((lambda *s: torch.randn(*s, dtype=torch.bfloat16) * 0.4)(C)),
    }

def reference(x, g, b):
    mu = x.mean(axis=(-2, -1), keepdims=True)
    var = ((x - mu) ** 2).mean(axis=(-2, -1), keepdims=True)
    xhat = (x - mu) / torch.sqrt(var + 1e-5)
    return xhat * g.reshape(1, -1, 1, 1) + b.reshape(1, -1, 1, 1)
```

```asm
; @launch grid=(448,1,1) block=(256,1,1) lds=65536
.amdgcn_target "amdgcn-amd-amdhsa--gfx950"
.text
.globl standalone__instancenorm__prompt_kernel
.p2align 8
.type standalone__instancenorm__prompt_kernel,@function
standalone__instancenorm__prompt_kernel:
  s_load_dwordx8 s[4:11], s[0:1], 0
  s_setprio 3
  s_and_b32 s17, s2, 3
  s_lshr_b32 s20, s2, 3
  s_mul_i32 s22, s17, 56
  s_bfe_u32 s24, s2, 0x10002
  s_add_u32 s22, s22, s20
  v_and_b32 v1, 63, v0
  v_lshrrev_b32 v2, 6, v0
  s_lshl1_add_u32 s27, s22, s24
  v_lshlrev_b32 v1, 4, v1
  s_lshl_b32 s27, s27, 17
  v_lshl_add_u32 v16, v2, 15, v1
  s_cmp_ge_u32 s20, 24
  v_add_u32 v16, s27, v16
  s_cbranch_scc1 L_late
  s_waitcnt lgkmcnt(0)
  global_load_dwordx4 v[24:27], v16, s[4:5] offset:0 nt
  global_load_dwordx4 v[28:31], v16, s[4:5] offset:1024 nt
  global_load_dwordx4 v[32:35], v16, s[4:5] offset:2048 nt
  global_load_dwordx4 v[36:39], v16, s[4:5] offset:3072 nt
  v_readfirstlane_b32 s16, v2
  s_movk_i32 s26, 0x1000
  v_add_u32 v17, s26, v16
  v_add_u32 v18, s26, v17
  v_add_u32 v19, s26, v18
  v_add_u32 v20, s26, v19
  v_add_u32 v21, s26, v20
  v_add_u32 v22, s26, v21
  v_add_u32 v23, s26, v22
  s_mov_b32 s33, 0
L_go4:
  global_load_dwordx4 v[40:43], v17, s[4:5] offset:0 nt
  global_load_dwordx4 v[44:47], v17, s[4:5] offset:1024 nt
  global_load_dwordx4 v[48:51], v17, s[4:5] offset:2048 nt
  global_load_dwordx4 v[52:55], v17, s[4:5] offset:3072 nt
  global_load_dwordx4 v[56:59], v18, s[4:5] offset:0 nt
  global_load_dwordx4 v[60:63], v18, s[4:5] offset:1024 nt
  global_load_dwordx4 v[64:67], v18, s[4:5] offset:2048 nt
  global_load_dwordx4 v[68:71], v18, s[4:5] offset:3072 nt
  global_load_dwordx4 v[72:75], v19, s[4:5] offset:0 nt
  global_load_dwordx4 v[76:79], v19, s[4:5] offset:1024 nt
  global_load_dwordx4 v[80:83], v19, s[4:5] offset:2048 nt
  global_load_dwordx4 v[84:87], v19, s[4:5] offset:3072 nt
  global_load_dwordx4 v[88:91], v20, s[4:5] offset:0 nt
  global_load_dwordx4 v[92:95], v20, s[4:5] offset:1024 nt
  global_load_dwordx4 v[96:99], v20, s[4:5] offset:2048 nt
  global_load_dwordx4 v[100:103], v20, s[4:5] offset:3072 nt
  global_load_dwordx4 v[104:107], v21, s[4:5] offset:0 nt
  global_load_dwordx4 v[108:111], v21, s[4:5] offset:1024 nt
  global_load_dwordx4 v[112:115], v21, s[4:5] offset:2048 nt
  global_load_dwordx4 v[116:119], v21, s[4:5] offset:3072 nt
  global_load_dwordx4 v[120:123], v22, s[4:5] offset:0 nt
  global_load_dwordx4 v[124:127], v22, s[4:5] offset:1024 nt
  global_load_dwordx4 v[128:131], v22, s[4:5] offset:2048 nt
  global_load_dwordx4 v[132:135], v22, s[4:5] offset:3072 nt
  global_load_dwordx4 v[136:139], v23, s[4:5] offset:0 nt
  global_load_dwordx4 v[140:143], v23, s[4:5] offset:1024 nt
  global_load_dwordx4 v[144:147], v23, s[4:5] offset:2048 nt
  global_load_dwordx4 v[148:151], v23, s[4:5] offset:3072 nt
  s_branch L_stats
L_late:
  s_cmp_ge_u32 s20, 56
  s_cbranch_scc1 L_end
  s_cmp_ge_u32 s20, 32
  s_cbranch_scc1 L_nowarm
  s_getpc_b64 s[52:53]
L_pc:
  v_lshlrev_b32 v6, 6, v0
  v_min_u32 v6, L_end-L_pc, v6
  v_mov_b32 v9, s53
  v_add_co_u32 v8, vcc, s52, v6
  s_nop 1
  v_addc_co_u32 v9, vcc, 0, v9, vcc
  global_load_dword v3, v[8:9], off
L_nowarm:
  s_load_dwordx2 s[14:15], s[0:1], 40
  v_readfirstlane_b32 s16, v2
  s_movk_i32 s26, 0x1000
  v_add_u32 v17, s26, v16
  v_add_u32 v18, s26, v17
  v_add_u32 v19, s26, v18
  v_add_u32 v20, s26, v19
  v_add_u32 v21, s26, v20
  v_add_u32 v22, s26, v21
  v_add_u32 v23, s26, v22
  s_mov_b32 s33, 0
  s_lshl_b32 s23, s22, 18
  s_cmp_lg_u32 s16, 0
  s_cbranch_scc1 L_other
  s_lshr_b32 s21, s22, 3
  s_and_b32 s59, s22, 1
  s_lshl1_add_u32 s21, s21, s59
  s_mul_i32 s12, s21, 1280
  s_mul_i32 s42, s2, 0x0b00
  s_and_b32 s43, s42, 0x1f00
  s_and_b32 s42, s42, 0xe000
  s_lshl1_add_u32 s42, s42, s43
  s_add_u32 s46, s42, s23
  s_lshl_b32 s42, s20, 11
  s_and_b32 s42, s42, 0x2000
  s_xor_b32 s43, s42, 0x2000
  s_lshr_b32 s18, s20, 1
  s_xor_b32 s19, s24, s18
  s_and_b32 s19, s19, 1
  s_waitcnt lgkmcnt(0)
  s_sub_u32 s59, s10, s4
  s_bitcmp1_b32 s59, 12
  s_cselect_b32 s47, s21, s19
  s_bitcmp1_b32 s47, 0
  s_cselect_b64 s[40:41], s[10:11], s[4:5]
  s_add_u32 s12, s14, s12
  s_addc_u32 s13, s15, 0
  s_and_b32 s47, s40, 0x3000
  s_sub_u32 s47, 0x4000, s47
  s_add_u32 s46, s46, s47
  s_add_u32 s40, s40, s46
  s_addc_u32 s41, s41, 0
  s_load_dword s28, s[12:13], 0 glc
  s_load_dword s44, s[40:41], s42 glc
  s_load_dword s44, s[40:41], s43 glc
  s_lshl_b32 s45, s22, 6
  s_add_u32 s45, s45, 0x80000
  s_load_dword s44, s[14:15], s45 glc
  s_and_b32 s18, s18, 3
  s_lshl_b32 s19, s19, 2
  s_or_b32 s18, s18, s19
  s_lshl_b32 s18, s18, 2
  s_add_u32 s18, s18, 64
  s_mov_b32 s34, 0
  s_waitcnt lgkmcnt(0)
  s_memtime s[50:51]
  s_lshr_b32 s19, s42, 13
  s_xor_b32 s19, s19, s24
  s_add_u32 s56, s28, 0x6b43a900
  s_andn2_b32 s56, s56, 0xff
  s_waitcnt lgkmcnt(0)
  s_load_dword s44, s[40:41], s42 glc
  s_waitcnt lgkmcnt(0)
  s_memtime s[52:53]
  s_waitcnt lgkmcnt(0)
  s_load_dword s44, s[40:41], s43 glc
  s_waitcnt lgkmcnt(0)
  s_memtime s[54:55]
  s_lshl_b32 s44, s52, 1
  s_sub_u32 s44, s44, s50
  s_waitcnt lgkmcnt(0)
  s_sub_u32 s44, s44, s54
  s_sub_u32 s46, 0, s44
  s_cmp_lg_u32 s19, 0
  s_cselect_b32 s44, s46, s44
  s_ashr_i32 s44, s44, 3
  s_min_i32 s44, s44, 127
  s_max_i32 s44, s44, -127
  s_add_u32 s44, s44, 128
  s_or_b32 s44, s44, s56
  s_atomic_swap s44, s[12:13], s18
  s_mov_b32 s57, s56
  s_mov_b32 s58, 0x6b43a900
  s_waitcnt lgkmcnt(0)
L_dpoll:
  s_load_dwordx8 s[36:43], s[12:13], 64 glc
  s_add_u32 s34, s34, 1
  s_waitcnt lgkmcnt(0)
  s_xor_b64 s[36:37], s[36:37], s[56:57]
  s_xor_b64 s[38:39], s[38:39], s[56:57]
  s_xor_b64 s[40:41], s[40:41], s[56:57]
  s_xor_b64 s[42:43], s[42:43], s[56:57]
  s_or_b64 s[54:55], s[36:37], s[38:39]
  s_or_b64 s[54:55], s[54:55], s[40:41]
  s_or_b64 s[54:55], s[54:55], s[42:43]
  s_or_b32 s54, s54, s55
  s_lshr_b32 s54, s54, 8
  s_cbranch_scc0 L_votes
  s_cmp_lt_u32 s34, 4096
  s_cbranch_scc1 L_dpoll
  s_atomic_add s58, s[12:13], 0
  s_mov_b32 s44, 6
  s_branch L_dgot
L_votes:
  s_cmp_lg_u32 s18, 64
  s_cbranch_scc1 L_nobump
  s_atomic_add s58, s[12:13], 0
L_nobump:
  s_add_u32 s36, s36, s37
  s_add_u32 s36, s36, s38
  s_add_u32 s36, s36, s39
  s_addk_i32 s36, -512
  s_add_u32 s40, s40, s41
  s_add_u32 s40, s40, s42
  s_add_u32 s40, s40, s43
  s_addk_i32 s40, -512
  s_add_u32 s46, s36, s40
  s_bitcmp1_b32 s59, 12
  s_cselect_b32 s44, s46, s40
  s_cselect_b32 s36, s46, s36
  s_abs_i32 s54, s36
  s_abs_i32 s55, s44
  s_min_u32 s54, s54, s55
  s_lshr_b32 s36, s36, 31
  s_lshr_b32 s44, s44, 31
  s_xor_b32 s46, s24, 1
  s_xor_b32 s36, s36, s46
  s_xor_b32 s44, s44, s46
  s_sub_u32 s46, s10, s4
  s_lshr_b32 s46, s46, 12
  s_xor_b32 s47, s36, s44
  s_lshl_b32 s47, s47, 1
  s_xor_b32 s46, s46, s47
  s_and_b32 s46, s46, 3
  s_cmp_eq_u32 s46, 2
  s_cselect_b32 s54, 0, s54
  s_lshl_b32 s36, s36, 3
  s_or_b32 s44, s36, s44
  s_or_b32 s44, s44, 2
  s_cmp_gt_u32 s54, 40
  s_cselect_b32 s44, s44, 0
L_dgot:
  s_or_b32 s44, s44, s56
  v_mov_b32 v6, 0
  v_mov_b32 v7, 0
  v_mov_b32 v8, s44
  ds_write_b96 v6, v[6:8] offset:64
  ds_write2_b32 v6, v6, v7 offset0:35 offset1:39
  s_waitcnt lgkmcnt(0)
L_dwait:
  v_mov_b32 v10, 0
  s_barrier
  ds_read_b32 v6, v10 offset:72
  s_waitcnt lgkmcnt(0)
  v_readfirstlane_b32 s44, v6
  s_bitcmp1_b32 s44, 1
  s_cbranch_scc0 L_go
  s_mov_b32 s33, 1
  s_bitcmp0_b32 s22, 0
  s_cselect_b32 s25, 3, 0
  s_cselect_b32 s49, s4, s10
  s_lshr_b32 s25, s44, s25
  s_and_b32 s25, s25, 1
  s_and_b32 s21, s49, 0x3000
  s_mov_b32 s26, s25
L_saddr:
  s_lshr_b32 s27, s16, 1
  s_lshl_b32 s27, s27, 17
  s_add_u32 s27, s27, s23
  v_and_b32 v1, 63, v0
  v_lshl_add_u32 v1, v1, 4, s27
  s_lshl_b32 s35, s16, 16
  s_lshl_b32 s27, s26, 13
  s_add_u32 s35, s35, s27
  s_sub_u32 s35, s35, s21
  s_mov_b32 s36, 0x1ffff
  s_and_b32 s27, s35, s36
  v_add_u32 v16, s27, v1
  s_addk_i32 s35, 0x1000
  s_and_b32 s27, s35, s36
  v_add_u32 v17, s27, v1
  s_addk_i32 s35, 0x3000
  s_and_b32 s27, s35, s36
  v_add_u32 v18, s27, v1
  s_addk_i32 s35, 0x1000
  s_and_b32 s27, s35, s36
  v_add_u32 v19, s27, v1
  s_addk_i32 s35, 0x3000
  s_and_b32 s27, s35, s36
  v_add_u32 v20, s27, v1
  s_addk_i32 s35, 0x1000
  s_and_b32 s27, s35, s36
  v_add_u32 v21, s27, v1
  s_addk_i32 s35, 0x3000
  s_and_b32 s27, s35, s36
  v_add_u32 v22, s27, v1
  s_addk_i32 s35, 0x1000
  s_and_b32 s27, s35, s36
  v_add_u32 v23, s27, v1
L_go:
  global_load_dwordx4 v[24:27], v16, s[4:5] offset:0 nt
  global_load_dwordx4 v[28:31], v16, s[4:5] offset:1024 nt
  global_load_dwordx4 v[32:35], v16, s[4:5] offset:2048 nt
  global_load_dwordx4 v[36:39], v16, s[4:5] offset:3072 nt
  s_branch L_go4
L_other:
  s_waitcnt lgkmcnt(0)
  s_branch L_dwait
L_stats:
  s_setprio 1
  s_lshl_b32 s27, s22, 2
  s_load_dword s29, s[6:7], s27
  s_load_dword s30, s[8:9], s27
  s_mov_b32 s31, 0xffff0000
  s_movk_i32 s50, 0x3f80
  s_mov_b32 s51, 1.0
  v_mov_b32 v6, 0
  v_mov_b32 v7, 0
  v_mov_b32 v8, 0
  v_mov_b32 v9, 0
  s_waitcnt vmcnt(31)
  v_readfirstlane_b32 s48, v24
  s_lshl_b32 s48, s48, 16
  s_xor_b32 s49, s48, 0x80000000
  v_mov_b32 v10, s49
  v_dot2_f32_bf16 v152, v24, s50, v10
  v_dot2_f32_bf16 v153, v24, s51, v10
  v_dot2_f32_bf16 v154, v25, s50, v10
  v_dot2_f32_bf16 v155, v25, s51, v10
  v_dot2_f32_bf16 v156, v26, s50, v10
  v_dot2_f32_bf16 v157, v26, s51, v10
  v_dot2_f32_bf16 v158, v27, s50, v10
  v_dot2_f32_bf16 v159, v27, s51, v10
  v_pk_add_f32 v[6:7], v[6:7], v[152:153]
  v_pk_fma_f32 v[8:9], v[152:153], v[152:153], v[8:9]
  v_pk_add_f32 v[6:7], v[6:7], v[154:155]
  v_pk_fma_f32 v[8:9], v[154:155], v[154:155], v[8:9]
  v_pk_add_f32 v[6:7], v[6:7], v[156:157]
  v_pk_fma_f32 v[8:9], v[156:157], v[156:157], v[8:9]
  v_pk_add_f32 v[6:7], v[6:7], v[158:159]
  v_pk_fma_f32 v[8:9], v[158:159], v[158:159], v[8:9]
  s_waitcnt vmcnt(30)
  v_dot2_f32_bf16 v152, v28, s50, v10
  v_dot2_f32_bf16 v153, v28, s51, v10
  v_dot2_f32_bf16 v154, v29, s50, v10
  v_dot2_f32_bf16 v155, v29, s51, v10
  v_dot2_f32_bf16 v156, v30, s50, v10
  v_dot2_f32_bf16 v157, v30, s51, v10
  v_dot2_f32_bf16 v158, v31, s50, v10
  v_dot2_f32_bf16 v159, v31, s51, v10
  v_pk_add_f32 v[6:7], v[6:7], v[152:153]
  v_pk_fma_f32 v[8:9], v[152:153], v[152:153], v[8:9]
  v_pk_add_f32 v[6:7], v[6:7], v[154:155]
  v_pk_fma_f32 v[8:9], v[154:155], v[154:155], v[8:9]
  v_pk_add_f32 v[6:7], v[6:7], v[156:157]
  v_pk_fma_f32 v[8:9], v[156:157], v[156:157], v[8:9]
  v_pk_add_f32 v[6:7], v[6:7], v[158:159]
  v_pk_fma_f32 v[8:9], v[158:159], v[158:159], v[8:9]
  s_waitcnt vmcnt(29)
  v_dot2_f32_bf16 v152, v32, s50, v10
  v_dot2_f32_bf16 v153, v32, s51, v10
  v_dot2_f32_bf16 v154, v33, s50, v10
  v_dot2_f32_bf16 v155, v33, s51, v10
  v_dot2_f32_bf16 v156, v34, s50, v10
  v_dot2_f32_bf16 v157, v34, s51, v10
  v_dot2_f32_bf16 v158, v35, s50, v10
  v_dot2_f32_bf16 v159, v35, s51, v10
  v_pk_add_f32 v[6:7], v[6:7], v[152:153]
  v_pk_fma_f32 v[8:9], v[152:153], v[152:153], v[8:9]
  v_pk_add_f32 v[6:7], v[6:7], v[154:155]
  v_pk_fma_f32 v[8:9], v[154:155], v[154:155], v[8:9]
  v_pk_add_f32 v[6:7], v[6:7], v[156:157]
  v_pk_fma_f32 v[8:9], v[156:157], v[156:157], v[8:9]
  v_pk_add_f32 v[6:7], v[6:7], v[158:159]
  v_pk_fma_f32 v[8:9], v[158:159], v[158:159], v[8:9]
  s_waitcnt vmcnt(28)
  v_dot2_f32_bf16 v152, v36, s50, v10
  v_dot2_f32_bf16 v153, v36, s51, v10
  v_dot2_f32_bf16 v154, v37, s50, v10
  v_dot2_f32_bf16 v155, v37, s51, v10
  v_dot2_f32_bf16 v156, v38, s50, v10
  v_dot2_f32_bf16 v157, v38, s51, v10
  v_dot2_f32_bf16 v158, v39, s50, v10
  v_dot2_f32_bf16 v159, v39, s51, v10
  v_pk_add_f32 v[6:7], v[6:7], v[152:153]
  v_pk_fma_f32 v[8:9], v[152:153], v[152:153], v[8:9]
  v_pk_add_f32 v[6:7], v[6:7], v[154:155]
  v_pk_fma_f32 v[8:9], v[154:155], v[154:155], v[8:9]
  v_pk_add_f32 v[6:7], v[6:7], v[156:157]
  v_pk_fma_f32 v[8:9], v[156:157], v[156:157], v[8:9]
  v_pk_add_f32 v[6:7], v[6:7], v[158:159]
  v_pk_fma_f32 v[8:9], v[158:159], v[158:159], v[8:9]
  s_waitcnt vmcnt(27)
  v_dot2_f32_bf16 v152, v40, s50, v10
  v_dot2_f32_bf16 v153, v40, s51, v10
  v_dot2_f32_bf16 v154, v41, s50, v10
  v_dot2_f32_bf16 v155, v41, s51, v10
  v_dot2_f32_bf16 v156, v42, s50, v10
  v_dot2_f32_bf16 v157, v42, s51, v10
  v_dot2_f32_bf16 v158, v43, s50, v10
  v_dot2_f32_bf16 v159, v43, s51, v10
  v_pk_add_f32 v[6:7], v[6:7], v[152:153]
  v_pk_fma_f32 v[8:9], v[152:153], v[152:153], v[8:9]
  v_pk_add_f32 v[6:7], v[6:7], v[154:155]
  v_pk_fma_f32 v[8:9], v[154:155], v[154:155], v[8:9]
  v_pk_add_f32 v[6:7], v[6:7], v[156:157]
  v_pk_fma_f32 v[8:9], v[156:157], v[156:157], v[8:9]
  v_pk_add_f32 v[6:7], v[6:7], v[158:159]
  v_pk_fma_f32 v[8:9], v[158:159], v[158:159], v[8:9]
  s_waitcnt vmcnt(26)
  v_dot2_f32_bf16 v152, v44, s50, v10
  v_dot2_f32_bf16 v153, v44, s51, v10
  v_dot2_f32_bf16 v154, v45, s50, v10
  v_dot2_f32_bf16 v155, v45, s51, v10
  v_dot2_f32_bf16 v156, v46, s50, v10
  v_dot2_f32_bf16 v157, v46, s51, v10
  v_dot2_f32_bf16 v158, v47, s50, v10
  v_dot2_f32_bf16 v159, v47, s51, v10
  v_pk_add_f32 v[6:7], v[6:7], v[152:153]
  v_pk_fma_f32 v[8:9], v[152:153], v[152:153], v[8:9]
  v_pk_add_f32 v[6:7], v[6:7], v[154:155]
  v_pk_fma_f32 v[8:9], v[154:155], v[154:155], v[8:9]
  v_pk_add_f32 v[6:7], v[6:7], v[156:157]
  v_pk_fma_f32 v[8:9], v[156:157], v[156:157], v[8:9]
  v_pk_add_f32 v[6:7], v[6:7], v[158:159]
  v_pk_fma_f32 v[8:9], v[158:159], v[158:159], v[8:9]
  s_waitcnt vmcnt(25)
  v_dot2_f32_bf16 v152, v48, s50, v10
  v_dot2_f32_bf16 v153, v48, s51, v10
  v_dot2_f32_bf16 v154, v49, s50, v10
  v_dot2_f32_bf16 v155, v49, s51, v10
  v_dot2_f32_bf16 v156, v50, s50, v10
  v_dot2_f32_bf16 v157, v50, s51, v10
  v_dot2_f32_bf16 v158, v51, s50, v10
  v_dot2_f32_bf16 v159, v51, s51, v10
  v_pk_add_f32 v[6:7], v[6:7], v[152:153]
  v_pk_fma_f32 v[8:9], v[152:153], v[152:153], v[8:9]
  v_pk_add_f32 v[6:7], v[6:7], v[154:155]
  v_pk_fma_f32 v[8:9], v[154:155], v[154:155], v[8:9]
  v_pk_add_f32 v[6:7], v[6:7], v[156:157]
  v_pk_fma_f32 v[8:9], v[156:157], v[156:157], v[8:9]
  v_pk_add_f32 v[6:7], v[6:7], v[158:159]
  v_pk_fma_f32 v[8:9], v[158:159], v[158:159], v[8:9]
  s_waitcnt vmcnt(24)
  v_dot2_f32_bf16 v152, v52, s50, v10
  v_dot2_f32_bf16 v153, v52, s51, v10
  v_dot2_f32_bf16 v154, v53, s50, v10
  v_dot2_f32_bf16 v155, v53, s51, v10
  v_dot2_f32_bf16 v156, v54, s50, v10
  v_dot2_f32_bf16 v157, v54, s51, v10
  v_dot2_f32_bf16 v158, v55, s50, v10
  v_dot2_f32_bf16 v159, v55, s51, v10
  v_pk_add_f32 v[6:7], v[6:7], v[152:153]
  v_pk_fma_f32 v[8:9], v[152:153], v[152:153], v[8:9]
  v_pk_add_f32 v[6:7], v[6:7], v[154:155]
  v_pk_fma_f32 v[8:9], v[154:155], v[154:155], v[8:9]
  v_pk_add_f32 v[6:7], v[6:7], v[156:157]
  v_pk_fma_f32 v[8:9], v[156:157], v[156:157], v[8:9]
  v_pk_add_f32 v[6:7], v[6:7], v[158:159]
  v_pk_fma_f32 v[8:9], v[158:159], v[158:159], v[8:9]
  s_waitcnt vmcnt(23)
  v_dot2_f32_bf16 v152, v56, s50, v10
  v_dot2_f32_bf16 v153, v56, s51, v10
  v_dot2_f32_bf16 v154, v57, s50, v10
  v_dot2_f32_bf16 v155, v57, s51, v10
  v_dot2_f32_bf16 v156, v58, s50, v10
  v_dot2_f32_bf16 v157, v58, s51, v10
  v_dot2_f32_bf16 v158, v59, s50, v10
  v_dot2_f32_bf16 v159, v59, s51, v10
  v_pk_add_f32 v[6:7], v[6:7], v[152:153]
  v_pk_fma_f32 v[8:9], v[152:153], v[152:153], v[8:9]
  v_pk_add_f32 v[6:7], v[6:7], v[154:155]
  v_pk_fma_f32 v[8:9], v[154:155], v[154:155], v[8:9]
  v_pk_add_f32 v[6:7], v[6:7], v[156:157]
  v_pk_fma_f32 v[8:9], v[156:157], v[156:157], v[8:9]
  v_pk_add_f32 v[6:7], v[6:7], v[158:159]
  v_pk_fma_f32 v[8:9], v[158:159], v[158:159], v[8:9]
  s_waitcnt vmcnt(22)
  v_dot2_f32_bf16 v152, v60, s50, v10
  v_dot2_f32_bf16 v153, v60, s51, v10
  v_dot2_f32_bf16 v154, v61, s50, v10
  v_dot2_f32_bf16 v155, v61, s51, v10
  v_dot2_f32_bf16 v156, v62, s50, v10
  v_dot2_f32_bf16 v157, v62, s51, v10
  v_dot2_f32_bf16 v158, v63, s50, v10
  v_dot2_f32_bf16 v159, v63, s51, v10
  v_pk_add_f32 v[6:7], v[6:7], v[152:153]
  v_pk_fma_f32 v[8:9], v[152:153], v[152:153], v[8:9]
  v_pk_add_f32 v[6:7], v[6:7], v[154:155]
  v_pk_fma_f32 v[8:9], v[154:155], v[154:155], v[8:9]
  v_pk_add_f32 v[6:7], v[6:7], v[156:157]
  v_pk_fma_f32 v[8:9], v[156:157], v[156:157], v[8:9]
  v_pk_add_f32 v[6:7], v[6:7], v[158:159]
  v_pk_fma_f32 v[8:9], v[158:159], v[158:159], v[8:9]
  s_waitcnt vmcnt(21)
  v_dot2_f32_bf16 v152, v64, s50, v10
  v_dot2_f32_bf16 v153, v64, s51, v10
  v_dot2_f32_bf16 v154, v65, s50, v10
  v_dot2_f32_bf16 v155, v65, s51, v10
  v_dot2_f32_bf16 v156, v66, s50, v10
  v_dot2_f32_bf16 v157, v66, s51, v10
  v_dot2_f32_bf16 v158, v67, s50, v10
  v_dot2_f32_bf16 v159, v67, s51, v10
  v_pk_add_f32 v[6:7], v[6:7], v[152:153]
  v_pk_fma_f32 v[8:9], v[152:153], v[152:153], v[8:9]
  v_pk_add_f32 v[6:7], v[6:7], v[154:155]
  v_pk_fma_f32 v[8:9], v[154:155], v[154:155], v[8:9]
  v_pk_add_f32 v[6:7], v[6:7], v[156:157]
  v_pk_fma_f32 v[8:9], v[156:157], v[156:157], v[8:9]
  v_pk_add_f32 v[6:7], v[6:7], v[158:159]
  v_pk_fma_f32 v[8:9], v[158:159], v[158:159], v[8:9]
  s_waitcnt vmcnt(20)
  v_dot2_f32_bf16 v152, v68, s50, v10
  v_dot2_f32_bf16 v153, v68, s51, v10
  v_dot2_f32_bf16 v154, v69, s50, v10
  v_dot2_f32_bf16 v155, v69, s51, v10
  v_dot2_f32_bf16 v156, v70, s50, v10
  v_dot2_f32_bf16 v157, v70, s51, v10
  v_dot2_f32_bf16 v158, v71, s50, v10
  v_dot2_f32_bf16 v159, v71, s51, v10
  v_pk_add_f32 v[6:7], v[6:7], v[152:153]
  v_pk_fma_f32 v[8:9], v[152:153], v[152:153], v[8:9]
  v_pk_add_f32 v[6:7], v[6:7], v[154:155]
  v_pk_fma_f32 v[8:9], v[154:155], v[154:155], v[8:9]
  v_pk_add_f32 v[6:7], v[6:7], v[156:157]
  v_pk_fma_f32 v[8:9], v[156:157], v[156:157], v[8:9]
  v_pk_add_f32 v[6:7], v[6:7], v[158:159]
  v_pk_fma_f32 v[8:9], v[158:159], v[158:159], v[8:9]
  s_waitcnt vmcnt(19)
  v_dot2_f32_bf16 v152, v72, s50, v10
  v_dot2_f32_bf16 v153, v72, s51, v10
  v_dot2_f32_bf16 v154, v73, s50, v10
  v_dot2_f32_bf16 v155, v73, s51, v10
  v_dot2_f32_bf16 v156, v74, s50, v10
  v_dot2_f32_bf16 v157, v74, s51, v10
  v_dot2_f32_bf16 v158, v75, s50, v10
  v_dot2_f32_bf16 v159, v75, s51, v10
  v_pk_add_f32 v[6:7], v[6:7], v[152:153]
  v_pk_fma_f32 v[8:9], v[152:153], v[152:153], v[8:9]
  v_pk_add_f32 v[6:7], v[6:7], v[154:155]
  v_pk_fma_f32 v[8:9], v[154:155], v[154:155], v[8:9]
  v_pk_add_f32 v[6:7], v[6:7], v[156:157]
  v_pk_fma_f32 v[8:9], v[156:157], v[156:157], v[8:9]
  v_pk_add_f32 v[6:7], v[6:7], v[158:159]
  v_pk_fma_f32 v[8:9], v[158:159], v[158:159], v[8:9]
  s_waitcnt vmcnt(18)
  v_dot2_f32_bf16 v152, v76, s50, v10
  v_dot2_f32_bf16 v153, v76, s51, v10
  v_dot2_f32_bf16 v154, v77, s50, v10
  v_dot2_f32_bf16 v155, v77, s51, v10
  v_dot2_f32_bf16 v156, v78, s50, v10
  v_dot2_f32_bf16 v157, v78, s51, v10
  v_dot2_f32_bf16 v158, v79, s50, v10
  v_dot2_f32_bf16 v159, v79, s51, v10
  v_pk_add_f32 v[6:7], v[6:7], v[152:153]
  v_pk_fma_f32 v[8:9], v[152:153], v[152:153], v[8:9]
  v_pk_add_f32 v[6:7], v[6:7], v[154:155]
  v_pk_fma_f32 v[8:9], v[154:155], v[154:155], v[8:9]
  v_pk_add_f32 v[6:7], v[6:7], v[156:157]
  v_pk_fma_f32 v[8:9], v[156:157], v[156:157], v[8:9]
  v_pk_add_f32 v[6:7], v[6:7], v[158:159]
  v_pk_fma_f32 v[8:9], v[158:159], v[158:159], v[8:9]
  s_waitcnt vmcnt(17)
  v_dot2_f32_bf16 v152, v80, s50, v10
  v_dot2_f32_bf16 v153, v80, s51, v10
  v_dot2_f32_bf16 v154, v81, s50, v10
  v_dot2_f32_bf16 v155, v81, s51, v10
  v_dot2_f32_bf16 v156, v82, s50, v10
  v_dot2_f32_bf16 v157, v82, s51, v10
  v_dot2_f32_bf16 v158, v83, s50, v10
  v_dot2_f32_bf16 v159, v83, s51, v10
  v_pk_add_f32 v[6:7], v[6:7], v[152:153]
  v_pk_fma_f32 v[8:9], v[152:153], v[152:153], v[8:9]
  v_pk_add_f32 v[6:7], v[6:7], v[154:155]
  v_pk_fma_f32 v[8:9], v[154:155], v[154:155], v[8:9]
  v_pk_add_f32 v[6:7], v[6:7], v[156:157]
  v_pk_fma_f32 v[8:9], v[156:157], v[156:157], v[8:9]
  v_pk_add_f32 v[6:7], v[6:7], v[158:159]
  v_pk_fma_f32 v[8:9], v[158:159], v[158:159], v[8:9]
  s_waitcnt vmcnt(16)
  v_dot2_f32_bf16 v152, v84, s50, v10
  v_dot2_f32_bf16 v153, v84, s51, v10
  v_dot2_f32_bf16 v154, v85, s50, v10
  v_dot2_f32_bf16 v155, v85, s51, v10
  v_dot2_f32_bf16 v156, v86, s50, v10
  v_dot2_f32_bf16 v157, v86, s51, v10
  v_dot2_f32_bf16 v158, v87, s50, v10
  v_dot2_f32_bf16 v159, v87, s51, v10
  v_pk_add_f32 v[6:7], v[6:7], v[152:153]
  v_pk_fma_f32 v[8:9], v[152:153], v[152:153], v[8:9]
  v_pk_add_f32 v[6:7], v[6:7], v[154:155]
  v_pk_fma_f32 v[8:9], v[154:155], v[154:155], v[8:9]
  v_pk_add_f32 v[6:7], v[6:7], v[156:157]
  v_pk_fma_f32 v[8:9], v[156:157], v[156:157], v[8:9]
  v_pk_add_f32 v[6:7], v[6:7], v[158:159]
  v_pk_fma_f32 v[8:9], v[158:159], v[158:159], v[8:9]
  s_waitcnt vmcnt(15)
  v_dot2_f32_bf16 v152, v88, s50, v10
  v_dot2_f32_bf16 v153, v88, s51, v10
  v_dot2_f32_bf16 v154, v89, s50, v10
  v_dot2_f32_bf16 v155, v89, s51, v10
  v_dot2_f32_bf16 v156, v90, s50, v10
  v_dot2_f32_bf16 v157, v90, s51, v10
  v_dot2_f32_bf16 v158, v91, s50, v10
  v_dot2_f32_bf16 v159, v91, s51, v10
  v_pk_add_f32 v[6:7], v[6:7], v[152:153]
  v_pk_fma_f32 v[8:9], v[152:153], v[152:153], v[8:9]
  v_pk_add_f32 v[6:7], v[6:7], v[154:155]
  v_pk_fma_f32 v[8:9], v[154:155], v[154:155], v[8:9]
  v_pk_add_f32 v[6:7], v[6:7], v[156:157]
  v_pk_fma_f32 v[8:9], v[156:157], v[156:157], v[8:9]
  v_pk_add_f32 v[6:7], v[6:7], v[158:159]
  v_pk_fma_f32 v[8:9], v[158:159], v[158:159], v[8:9]
  s_waitcnt vmcnt(14)
  v_dot2_f32_bf16 v152, v92, s50, v10
  v_dot2_f32_bf16 v153, v92, s51, v10
  v_dot2_f32_bf16 v154, v93, s50, v10
  v_dot2_f32_bf16 v155, v93, s51, v10
  v_dot2_f32_bf16 v156, v94, s50, v10
  v_dot2_f32_bf16 v157, v94, s51, v10
  v_dot2_f32_bf16 v158, v95, s50, v10
  v_dot2_f32_bf16 v159, v95, s51, v10
  v_pk_add_f32 v[6:7], v[6:7], v[152:153]
  v_pk_fma_f32 v[8:9], v[152:153], v[152:153], v[8:9]
  v_pk_add_f32 v[6:7], v[6:7], v[154:155]
  v_pk_fma_f32 v[8:9], v[154:155], v[154:155], v[8:9]
  v_pk_add_f32 v[6:7], v[6:7], v[156:157]
  v_pk_fma_f32 v[8:9], v[156:157], v[156:157], v[8:9]
  v_pk_add_f32 v[6:7], v[6:7], v[158:159]
  v_pk_fma_f32 v[8:9], v[158:159], v[158:159], v[8:9]
  s_waitcnt vmcnt(13)
  v_dot2_f32_bf16 v152, v96, s50, v10
  v_dot2_f32_bf16 v153, v96, s51, v10
  v_dot2_f32_bf16 v154, v97, s50, v10
  v_dot2_f32_bf16 v155, v97, s51, v10
  v_dot2_f32_bf16 v156, v98, s50, v10
  v_dot2_f32_bf16 v157, v98, s51, v10
  v_dot2_f32_bf16 v158, v99, s50, v10
  v_dot2_f32_bf16 v159, v99, s51, v10
  v_pk_add_f32 v[6:7], v[6:7], v[152:153]
  v_pk_fma_f32 v[8:9], v[152:153], v[152:153], v[8:9]
  v_pk_add_f32 v[6:7], v[6:7], v[154:155]
  v_pk_fma_f32 v[8:9], v[154:155], v[154:155], v[8:9]
  v_pk_add_f32 v[6:7], v[6:7], v[156:157]
  v_pk_fma_f32 v[8:9], v[156:157], v[156:157], v[8:9]
  v_pk_add_f32 v[6:7], v[6:7], v[158:159]
  v_pk_fma_f32 v[8:9], v[158:159], v[158:159], v[8:9]
  s_waitcnt vmcnt(12)
  v_dot2_f32_bf16 v152, v100, s50, v10
  v_dot2_f32_bf16 v153, v100, s51, v10
  v_dot2_f32_bf16 v154, v101, s50, v10
  v_dot2_f32_bf16 v155, v101, s51, v10
  v_dot2_f32_bf16 v156, v102, s50, v10
  v_dot2_f32_bf16 v157, v102, s51, v10
  v_dot2_f32_bf16 v158, v103, s50, v10
  v_dot2_f32_bf16 v159, v103, s51, v10
  v_pk_add_f32 v[6:7], v[6:7], v[152:153]
  v_pk_fma_f32 v[8:9], v[152:153], v[152:153], v[8:9]
  v_pk_add_f32 v[6:7], v[6:7], v[154:155]
  v_pk_fma_f32 v[8:9], v[154:155], v[154:155], v[8:9]
  v_pk_add_f32 v[6:7], v[6:7], v[156:157]
  v_pk_fma_f32 v[8:9], v[156:157], v[156:157], v[8:9]
  v_pk_add_f32 v[6:7], v[6:7], v[158:159]
  v_pk_fma_f32 v[8:9], v[158:159], v[158:159], v[8:9]
  s_waitcnt vmcnt(11)
  v_dot2_f32_bf16 v152, v104, s50, v10
  v_dot2_f32_bf16 v153, v104, s51, v10
  v_dot2_f32_bf16 v154, v105, s50, v10
  v_dot2_f32_bf16 v155, v105, s51, v10
  v_dot2_f32_bf16 v156, v106, s50, v10
  v_dot2_f32_bf16 v157, v106, s51, v10
  v_dot2_f32_bf16 v158, v107, s50, v10
  v_dot2_f32_bf16 v159, v107, s51, v10
  v_pk_add_f32 v[6:7], v[6:7], v[152:153]
  v_pk_fma_f32 v[8:9], v[152:153], v[152:153], v[8:9]
  v_pk_add_f32 v[6:7], v[6:7], v[154:155]
  v_pk_fma_f32 v[8:9], v[154:155], v[154:155], v[8:9]
  v_pk_add_f32 v[6:7], v[6:7], v[156:157]
  v_pk_fma_f32 v[8:9], v[156:157], v[156:157], v[8:9]
  v_pk_add_f32 v[6:7], v[6:7], v[158:159]
  v_pk_fma_f32 v[8:9], v[158:159], v[158:159], v[8:9]
  s_waitcnt vmcnt(10)
  v_dot2_f32_bf16 v152, v108, s50, v10
  v_dot2_f32_bf16 v153, v108, s51, v10
  v_dot2_f32_bf16 v154, v109, s50, v10
  v_dot2_f32_bf16 v155, v109, s51, v10
  v_dot2_f32_bf16 v156, v110, s50, v10
  v_dot2_f32_bf16 v157, v110, s51, v10
  v_dot2_f32_bf16 v158, v111, s50, v10
  v_dot2_f32_bf16 v159, v111, s51, v10
  v_pk_add_f32 v[6:7], v[6:7], v[152:153]
  v_pk_fma_f32 v[8:9], v[152:153], v[152:153], v[8:9]
  v_pk_add_f32 v[6:7], v[6:7], v[154:155]
  v_pk_fma_f32 v[8:9], v[154:155], v[154:155], v[8:9]
  v_pk_add_f32 v[6:7], v[6:7], v[156:157]
  v_pk_fma_f32 v[8:9], v[156:157], v[156:157], v[8:9]
  v_pk_add_f32 v[6:7], v[6:7], v[158:159]
  v_pk_fma_f32 v[8:9], v[158:159], v[158:159], v[8:9]
  s_waitcnt vmcnt(9)
  v_dot2_f32_bf16 v152, v112, s50, v10
  v_dot2_f32_bf16 v153, v112, s51, v10
  v_dot2_f32_bf16 v154, v113, s50, v10
  v_dot2_f32_bf16 v155, v113, s51, v10
  v_dot2_f32_bf16 v156, v114, s50, v10
  v_dot2_f32_bf16 v157, v114, s51, v10
  v_dot2_f32_bf16 v158, v115, s50, v10
  v_dot2_f32_bf16 v159, v115, s51, v10
  v_pk_add_f32 v[6:7], v[6:7], v[152:153]
  v_pk_fma_f32 v[8:9], v[152:153], v[152:153], v[8:9]
  v_pk_add_f32 v[6:7], v[6:7], v[154:155]
  v_pk_fma_f32 v[8:9], v[154:155], v[154:155], v[8:9]
  v_pk_add_f32 v[6:7], v[6:7], v[156:157]
  v_pk_fma_f32 v[8:9], v[156:157], v[156:157], v[8:9]
  v_pk_add_f32 v[6:7], v[6:7], v[158:159]
  v_pk_fma_f32 v[8:9], v[158:159], v[158:159], v[8:9]
  s_waitcnt vmcnt(8)
  v_dot2_f32_bf16 v152, v116, s50, v10
  v_dot2_f32_bf16 v153, v116, s51, v10
  v_dot2_f32_bf16 v154, v117, s50, v10
  v_dot2_f32_bf16 v155, v117, s51, v10
  v_dot2_f32_bf16 v156, v118, s50, v10
  v_dot2_f32_bf16 v157, v118, s51, v10
  v_dot2_f32_bf16 v158, v119, s50, v10
  v_dot2_f32_bf16 v159, v119, s51, v10
  v_pk_add_f32 v[6:7], v[6:7], v[152:153]
  v_pk_fma_f32 v[8:9], v[152:153], v[152:153], v[8:9]
  v_pk_add_f32 v[6:7], v[6:7], v[154:155]
  v_pk_fma_f32 v[8:9], v[154:155], v[154:155], v[8:9]
  v_pk_add_f32 v[6:7], v[6:7], v[156:157]
  v_pk_fma_f32 v[8:9], v[156:157], v[156:157], v[8:9]
  v_pk_add_f32 v[6:7], v[6:7], v[158:159]
  v_pk_fma_f32 v[8:9], v[158:159], v[158:159], v[8:9]
  s_waitcnt vmcnt(7)
  v_dot2_f32_bf16 v152, v120, s50, v10
  v_dot2_f32_bf16 v153, v120, s51, v10
  v_dot2_f32_bf16 v154, v121, s50, v10
  v_dot2_f32_bf16 v155, v121, s51, v10
  v_dot2_f32_bf16 v156, v122, s50, v10
  v_dot2_f32_bf16 v157, v122, s51, v10
  v_dot2_f32_bf16 v158, v123, s50, v10
  v_dot2_f32_bf16 v159, v123, s51, v10
  v_pk_add_f32 v[6:7], v[6:7], v[152:153]
  v_pk_fma_f32 v[8:9], v[152:153], v[152:153], v[8:9]
  v_pk_add_f32 v[6:7], v[6:7], v[154:155]
  v_pk_fma_f32 v[8:9], v[154:155], v[154:155], v[8:9]
  v_pk_add_f32 v[6:7], v[6:7], v[156:157]
  v_pk_fma_f32 v[8:9], v[156:157], v[156:157], v[8:9]
  v_pk_add_f32 v[6:7], v[6:7], v[158:159]
  v_pk_fma_f32 v[8:9], v[158:159], v[158:159], v[8:9]
  s_waitcnt vmcnt(6)
  v_dot2_f32_bf16 v152, v124, s50, v10
  v_dot2_f32_bf16 v153, v124, s51, v10
  v_dot2_f32_bf16 v154, v125, s50, v10
  v_dot2_f32_bf16 v155, v125, s51, v10
  v_dot2_f32_bf16 v156, v126, s50, v10
  v_dot2_f32_bf16 v157, v126, s51, v10
  v_dot2_f32_bf16 v158, v127, s50, v10
  v_dot2_f32_bf16 v159, v127, s51, v10
  v_pk_add_f32 v[6:7], v[6:7], v[152:153]
  v_pk_fma_f32 v[8:9], v[152:153], v[152:153], v[8:9]
  v_pk_add_f32 v[6:7], v[6:7], v[154:155]
  v_pk_fma_f32 v[8:9], v[154:155], v[154:155], v[8:9]
  v_pk_add_f32 v[6:7], v[6:7], v[156:157]
  v_pk_fma_f32 v[8:9], v[156:157], v[156:157], v[8:9]
  v_pk_add_f32 v[6:7], v[6:7], v[158:159]
  v_pk_fma_f32 v[8:9], v[158:159], v[158:159], v[8:9]
  s_waitcnt vmcnt(5)
  v_dot2_f32_bf16 v152, v128, s50, v10
  v_dot2_f32_bf16 v153, v128, s51, v10
  v_dot2_f32_bf16 v154, v129, s50, v10
  v_dot2_f32_bf16 v155, v129, s51, v10
  v_dot2_f32_bf16 v156, v130, s50, v10
  v_dot2_f32_bf16 v157, v130, s51, v10
  v_dot2_f32_bf16 v158, v131, s50, v10
  v_dot2_f32_bf16 v159, v131, s51, v10
  v_pk_add_f32 v[6:7], v[6:7], v[152:153]
  v_pk_fma_f32 v[8:9], v[152:153], v[152:153], v[8:9]
  v_pk_add_f32 v[6:7], v[6:7], v[154:155]
  v_pk_fma_f32 v[8:9], v[154:155], v[154:155], v[8:9]
  v_pk_add_f32 v[6:7], v[6:7], v[156:157]
  v_pk_fma_f32 v[8:9], v[156:157], v[156:157], v[8:9]
  v_pk_add_f32 v[6:7], v[6:7], v[158:159]
  v_pk_fma_f32 v[8:9], v[158:159], v[158:159], v[8:9]
  s_waitcnt vmcnt(4)
  v_dot2_f32_bf16 v152, v132, s50, v10
  v_dot2_f32_bf16 v153, v132, s51, v10
  v_dot2_f32_bf16 v154, v133, s50, v10
  v_dot2_f32_bf16 v155, v133, s51, v10
  v_dot2_f32_bf16 v156, v134, s50, v10
  v_dot2_f32_bf16 v157, v134, s51, v10
  v_dot2_f32_bf16 v158, v135, s50, v10
  v_dot2_f32_bf16 v159, v135, s51, v10
  v_pk_add_f32 v[6:7], v[6:7], v[152:153]
  v_pk_fma_f32 v[8:9], v[152:153], v[152:153], v[8:9]
  v_pk_add_f32 v[6:7], v[6:7], v[154:155]
  v_pk_fma_f32 v[8:9], v[154:155], v[154:155], v[8:9]
  v_pk_add_f32 v[6:7], v[6:7], v[156:157]
  v_pk_fma_f32 v[8:9], v[156:157], v[156:157], v[8:9]
  v_pk_add_f32 v[6:7], v[6:7], v[158:159]
  v_pk_fma_f32 v[8:9], v[158:159], v[158:159], v[8:9]
  s_waitcnt vmcnt(3)
  v_dot2_f32_bf16 v152, v136, s50, v10
  v_dot2_f32_bf16 v153, v136, s51, v10
  v_dot2_f32_bf16 v154, v137, s50, v10
  v_dot2_f32_bf16 v155, v137, s51, v10
  v_dot2_f32_bf16 v156, v138, s50, v10
  v_dot2_f32_bf16 v157, v138, s51, v10
  v_dot2_f32_bf16 v158, v139, s50, v10
  v_dot2_f32_bf16 v159, v139, s51, v10
  v_pk_add_f32 v[6:7], v[6:7], v[152:153]
  v_pk_fma_f32 v[8:9], v[152:153], v[152:153], v[8:9]
  v_pk_add_f32 v[6:7], v[6:7], v[154:155]
  v_pk_fma_f32 v[8:9], v[154:155], v[154:155], v[8:9]
  v_pk_add_f32 v[6:7], v[6:7], v[156:157]
  v_pk_fma_f32 v[8:9], v[156:157], v[156:157], v[8:9]
  v_pk_add_f32 v[6:7], v[6:7], v[158:159]
  v_pk_fma_f32 v[8:9], v[158:159], v[158:159], v[8:9]
  s_waitcnt vmcnt(2)
  v_dot2_f32_bf16 v152, v140, s50, v10
  v_dot2_f32_bf16 v153, v140, s51, v10
  v_dot2_f32_bf16 v154, v141, s50, v10
  v_dot2_f32_bf16 v155, v141, s51, v10
  v_dot2_f32_bf16 v156, v142, s50, v10
  v_dot2_f32_bf16 v157, v142, s51, v10
  v_dot2_f32_bf16 v158, v143, s50, v10
  v_dot2_f32_bf16 v159, v143, s51, v10
  v_pk_add_f32 v[6:7], v[6:7], v[152:153]
  v_pk_fma_f32 v[8:9], v[152:153], v[152:153], v[8:9]
  v_pk_add_f32 v[6:7], v[6:7], v[154:155]
  v_pk_fma_f32 v[8:9], v[154:155], v[154:155], v[8:9]
  v_pk_add_f32 v[6:7], v[6:7], v[156:157]
  v_pk_fma_f32 v[8:9], v[156:157], v[156:157], v[8:9]
  v_pk_add_f32 v[6:7], v[6:7], v[158:159]
  v_pk_fma_f32 v[8:9], v[158:159], v[158:159], v[8:9]
  s_waitcnt vmcnt(1)
  v_dot2_f32_bf16 v152, v144, s50, v10
  v_dot2_f32_bf16 v153, v144, s51, v10
  v_dot2_f32_bf16 v154, v145, s50, v10
  v_dot2_f32_bf16 v155, v145, s51, v10
  v_dot2_f32_bf16 v156, v146, s50, v10
  v_dot2_f32_bf16 v157, v146, s51, v10
  v_dot2_f32_bf16 v158, v147, s50, v10
  v_dot2_f32_bf16 v159, v147, s51, v10
  v_pk_add_f32 v[6:7], v[6:7], v[152:153]
  v_pk_fma_f32 v[8:9], v[152:153], v[152:153], v[8:9]
  v_pk_add_f32 v[6:7], v[6:7], v[154:155]
  v_pk_fma_f32 v[8:9], v[154:155], v[154:155], v[8:9]
  v_pk_add_f32 v[6:7], v[6:7], v[156:157]
  v_pk_fma_f32 v[8:9], v[156:157], v[156:157], v[8:9]
  v_pk_add_f32 v[6:7], v[6:7], v[158:159]
  v_pk_fma_f32 v[8:9], v[158:159], v[158:159], v[8:9]
  s_waitcnt vmcnt(0)
  v_dot2_f32_bf16 v152, v148, s50, v10
  v_dot2_f32_bf16 v153, v148, s51, v10
  v_dot2_f32_bf16 v154, v149, s50, v10
  v_dot2_f32_bf16 v155, v149, s51, v10
  v_dot2_f32_bf16 v156, v150, s50, v10
  v_dot2_f32_bf16 v157, v150, s51, v10
  v_dot2_f32_bf16 v158, v151, s50, v10
  v_dot2_f32_bf16 v159, v151, s51, v10
  v_pk_add_f32 v[6:7], v[6:7], v[152:153]
  v_pk_fma_f32 v[8:9], v[152:153], v[152:153], v[8:9]
  v_pk_add_f32 v[6:7], v[6:7], v[154:155]
  v_pk_fma_f32 v[8:9], v[154:155], v[154:155], v[8:9]
  v_pk_add_f32 v[6:7], v[6:7], v[156:157]
  v_pk_fma_f32 v[8:9], v[156:157], v[156:157], v[8:9]
  v_pk_add_f32 v[6:7], v[6:7], v[158:159]
  v_pk_fma_f32 v[8:9], v[158:159], v[158:159], v[8:9]
  v_add_f32 v6, v6, v7
  v_add_f32 v7, v8, v9
  s_lshl_b32 s27, s16, 3
  v_add_f32_dpp v6, v6, v6 quad_perm:[1,0,3,2] row_mask:0xf bank_mask:0xf
  v_add_f32_dpp v7, v7, v7 quad_perm:[1,0,3,2] row_mask:0xf bank_mask:0xf
  v_mov_b32 v10, s27
  v_add_f32_dpp v6, v6, v6 quad_perm:[2,3,0,1] row_mask:0xf bank_mask:0xf
  v_add_f32_dpp v7, v7, v7 quad_perm:[2,3,0,1] row_mask:0xf bank_mask:0xf
  v_and_b32 v11, 3, v0
  v_add_f32_dpp v6, v6, v6 row_half_mirror row_mask:0xf bank_mask:0xf
  v_add_f32_dpp v7, v7, v7 row_half_mirror row_mask:0xf bank_mask:0xf
  v_lshlrev_b32 v11, 3, v11
  v_add_f32_dpp v6, v6, v6 row_mirror row_mask:0xf bank_mask:0xf
  v_add_f32_dpp v7, v7, v7 row_mirror row_mask:0xf bank_mask:0xf
  s_nop 0
  v_add_f32_dpp v6, v6, v6 row_bcast:15 row_mask:0xa bank_mask:0xf
  v_add_f32_dpp v7, v7, v7 row_bcast:15 row_mask:0xa bank_mask:0xf
  s_nop 0
  v_add_f32_dpp v6, v6, v6 row_bcast:31 row_mask:0xc bank_mask:0xf
  v_add_f32_dpp v7, v7, v7 row_bcast:31 row_mask:0xc bank_mask:0xf
  s_nop 0
  v_mul_f32 v8, 0x38800000, v6
  v_fma_f32 v7, -v8, v6, v7
  v_add_f32 v6, s48, v8
  s_mov_b32 exec_lo, 0
  s_brev_b32 exec_hi, 1
  ds_write_b64 v10, v[6:7]
  s_cmp_lg_u32 s33, 0
  s_cbranch_scc1 L_split
  s_mov_b64 exec, -1
  s_waitcnt lgkmcnt(0)
  s_barrier
  ds_read_b64 v[6:7], v11
  s_lshl_b32 s27, s24, 4
  s_xor_b32 s27, s27, 16
  s_lshl_b32 s35, s29, s27
  s_lshl_b32 s27, s30, s27
  s_and_b32 s35, s35, s31
  s_and_b32 s27, s27, s31
  s_waitcnt lgkmcnt(0)
  v_add_f32_dpp v8, v6, v6 quad_perm:[1,0,3,2] row_mask:0xf bank_mask:0xf
  s_nop 1
  v_add_f32_dpp v8, v8, v8 quad_perm:[2,3,0,1] row_mask:0xf bank_mask:0xf
  v_mul_f32 v8, 0x3e800000, v8
  v_sub_f32 v6, v6, v8
  v_mul_f32 v10, 0x46800000, v6
  v_fmac_f32 v7, v10, v6
  s_nop 1
  v_add_f32_dpp v7, v7, v7 quad_perm:[1,0,3,2] row_mask:0xf bank_mask:0xf
  s_nop 1
  v_add_f32_dpp v7, v7, v7 quad_perm:[2,3,0,1] row_mask:0xf bank_mask:0xf
  v_cvt_pk_bf16_f32 v10, v8, v8
  v_and_b32 v10, s31, v10
  v_sub_f32 v8, v8, v10
  v_mul_f32 v8, v8, v8
  v_fmac_f32 v8, 0x37800000, v7
  v_max_f32 v8, 0, v8
  v_cvt_pk_bf16_f32 v8, v8, v8
  v_and_b32 v8, s31, v8
  v_add_f32 v8, 0x3727c5ac, v8
  v_cvt_pk_bf16_f32 v8, v8, v8
  v_and_b32 v8, s31, v8
  v_sqrt_f32 v8, v8
  v_mov_b32 v9, s27
  v_cvt_pk_bf16_f32 v8, v8, v8
  v_and_b32 v8, s31, v8
  v_rcp_f32 v8, v8
  s_nop 0
  v_mul_f32 v8, s35, v8
  s_cmp_lt_u32 s20, 24
  s_cbranch_scc0 L_norm
  s_setprio 3
L_norm:
  s_cmp_lt_u32 s20, 24
  s_cbranch_scc1 L_lp
  s_setprio 0
L_lp:
  s_movk_i32 s36, 0x3f80
  s_mov_b32 s37, 1.0
  v_xor_b32 v10, 0x80000000, v10
  v_dot2_f32_bf16 v152, v24, s36, v10
  v_dot2_f32_bf16 v153, v24, s37, v10
  v_dot2_f32_bf16 v154, v25, s36, v10
  v_dot2_f32_bf16 v155, v25, s37, v10
  v_dot2_f32_bf16 v156, v26, s36, v10
  v_dot2_f32_bf16 v157, v26, s37, v10
  v_dot2_f32_bf16 v158, v27, s36, v10
  v_dot2_f32_bf16 v159, v27, s37, v10
  v_pk_fma_f32 v[152:153], v[152:153], v[8:9], v[8:9] op_sel:[0,0,1] op_sel_hi:[1,0,1]
  v_pk_fma_f32 v[154:155], v[154:155], v[8:9], v[8:9] op_sel:[0,0,1] op_sel_hi:[1,0,1]
  v_pk_fma_f32 v[156:157], v[156:157], v[8:9], v[8:9] op_sel:[0,0,1] op_sel_hi:[1,0,1]
  v_pk_fma_f32 v[158:159], v[158:159], v[8:9], v[8:9] op_sel:[0,0,1] op_sel_hi:[1,0,1]
  v_cvt_pk_bf16_f32 v24, v152, v153
  v_cvt_pk_bf16_f32 v25, v154, v155
  v_cvt_pk_bf16_f32 v26, v156, v157
  v_cvt_pk_bf16_f32 v27, v158, v159
  global_store_dwordx4 v16, v[24:27], s[10:11] offset:0 sc1
  v_dot2_f32_bf16 v152, v28, s36, v10
  v_dot2_f32_bf16 v153, v28, s37, v10
  v_dot2_f32_bf16 v154, v29, s36, v10
  v_dot2_f32_bf16 v155, v29, s37, v10
  v_dot2_f32_bf16 v156, v30, s36, v10
  v_dot2_f32_bf16 v157, v30, s37, v10
  v_dot2_f32_bf16 v158, v31, s36, v10
  v_dot2_f32_bf16 v159, v31, s37, v10
  v_pk_fma_f32 v[152:153], v[152:153], v[8:9], v[8:9] op_sel:[0,0,1] op_sel_hi:[1,0,1]
  v_pk_fma_f32 v[154:155], v[154:155], v[8:9], v[8:9] op_sel:[0,0,1] op_sel_hi:[1,0,1]
  v_pk_fma_f32 v[156:157], v[156:157], v[8:9], v[8:9] op_sel:[0,0,1] op_sel_hi:[1,0,1]
  v_pk_fma_f32 v[158:159], v[158:159], v[8:9], v[8:9] op_sel:[0,0,1] op_sel_hi:[1,0,1]
  v_cvt_pk_bf16_f32 v28, v152, v153
  v_cvt_pk_bf16_f32 v29, v154, v155
  v_cvt_pk_bf16_f32 v30, v156, v157
  v_cvt_pk_bf16_f32 v31, v158, v159
  global_store_dwordx4 v16, v[28:31], s[10:11] offset:1024 sc1
  v_dot2_f32_bf16 v152, v32, s36, v10
  v_dot2_f32_bf16 v153, v32, s37, v10
  v_dot2_f32_bf16 v154, v33, s36, v10
  v_dot2_f32_bf16 v155, v33, s37, v10
  v_dot2_f32_bf16 v156, v34, s36, v10
  v_dot2_f32_bf16 v157, v34, s37, v10
  v_dot2_f32_bf16 v158, v35, s36, v10
  v_dot2_f32_bf16 v159, v35, s37, v10
  v_pk_fma_f32 v[152:153], v[152:153], v[8:9], v[8:9] op_sel:[0,0,1] op_sel_hi:[1,0,1]
  v_pk_fma_f32 v[154:155], v[154:155], v[8:9], v[8:9] op_sel:[0,0,1] op_sel_hi:[1,0,1]
  v_pk_fma_f32 v[156:157], v[156:157], v[8:9], v[8:9] op_sel:[0,0,1] op_sel_hi:[1,0,1]
  v_pk_fma_f32 v[158:159], v[158:159], v[8:9], v[8:9] op_sel:[0,0,1] op_sel_hi:[1,0,1]
  v_cvt_pk_bf16_f32 v32, v152, v153
  v_cvt_pk_bf16_f32 v33, v154, v155
  v_cvt_pk_bf16_f32 v34, v156, v157
  v_cvt_pk_bf16_f32 v35, v158, v159
  global_store_dwordx4 v16, v[32:35], s[10:11] offset:2048 sc1
  v_dot2_f32_bf16 v152, v36, s36, v10
  v_dot2_f32_bf16 v153, v36, s37, v10
  v_dot2_f32_bf16 v154, v37, s36, v10
  v_dot2_f32_bf16 v155, v37, s37, v10
  v_dot2_f32_bf16 v156, v38, s36, v10
  v_dot2_f32_bf16 v157, v38, s37, v10
  v_dot2_f32_bf16 v158, v39, s36, v10
  v_dot2_f32_bf16 v159, v39, s37, v10
  v_pk_fma_f32 v[152:153], v[152:153], v[8:9], v[8:9] op_sel:[0,0,1] op_sel_hi:[1,0,1]
  v_pk_fma_f32 v[154:155], v[154:155], v[8:9], v[8:9] op_sel:[0,0,1] op_sel_hi:[1,0,1]
  v_pk_fma_f32 v[156:157], v[156:157], v[8:9], v[8:9] op_sel:[0,0,1] op_sel_hi:[1,0,1]
  v_pk_fma_f32 v[158:159], v[158:159], v[8:9], v[8:9] op_sel:[0,0,1] op_sel_hi:[1,0,1]
  v_cvt_pk_bf16_f32 v36, v152, v153
  v_cvt_pk_bf16_f32 v37, v154, v155
  v_cvt_pk_bf16_f32 v38, v156, v157
  v_cvt_pk_bf16_f32 v39, v158, v159
  global_store_dwordx4 v16, v[36:39], s[10:11] offset:3072 sc1
  v_dot2_f32_bf16 v152, v40, s36, v10
  v_dot2_f32_bf16 v153, v40, s37, v10
  v_dot2_f32_bf16 v154, v41, s36, v10
  v_dot2_f32_bf16 v155, v41, s37, v10
  v_dot2_f32_bf16 v156, v42, s36, v10
  v_dot2_f32_bf16 v157, v42, s37, v10
  v_dot2_f32_bf16 v158, v43, s36, v10
  v_dot2_f32_bf16 v159, v43, s37, v10
  v_pk_fma_f32 v[152:153], v[152:153], v[8:9], v[8:9] op_sel:[0,0,1] op_sel_hi:[1,0,1]
  v_pk_fma_f32 v[154:155], v[154:155], v[8:9], v[8:9] op_sel:[0,0,1] op_sel_hi:[1,0,1]
  v_pk_fma_f32 v[156:157], v[156:157], v[8:9], v[8:9] op_sel:[0,0,1] op_sel_hi:[1,0,1]
  v_pk_fma_f32 v[158:159], v[158:159], v[8:9], v[8:9] op_sel:[0,0,1] op_sel_hi:[1,0,1]
  v_cvt_pk_bf16_f32 v40, v152, v153
  v_cvt_pk_bf16_f32 v41, v154, v155
  v_cvt_pk_bf16_f32 v42, v156, v157
  v_cvt_pk_bf16_f32 v43, v158, v159
  global_store_dwordx4 v17, v[40:43], s[10:11] offset:0 sc1
  v_dot2_f32_bf16 v152, v44, s36, v10
  v_dot2_f32_bf16 v153, v44, s37, v10
  v_dot2_f32_bf16 v154, v45, s36, v10
  v_dot2_f32_bf16 v155, v45, s37, v10
  v_dot2_f32_bf16 v156, v46, s36, v10
  v_dot2_f32_bf16 v157, v46, s37, v10
  v_dot2_f32_bf16 v158, v47, s36, v10
  v_dot2_f32_bf16 v159, v47, s37, v10
  v_pk_fma_f32 v[152:153], v[152:153], v[8:9], v[8:9] op_sel:[0,0,1] op_sel_hi:[1,0,1]
  v_pk_fma_f32 v[154:155], v[154:155], v[8:9], v[8:9] op_sel:[0,0,1] op_sel_hi:[1,0,1]
  v_pk_fma_f32 v[156:157], v[156:157], v[8:9], v[8:9] op_sel:[0,0,1] op_sel_hi:[1,0,1]
  v_pk_fma_f32 v[158:159], v[158:159], v[8:9], v[8:9] op_sel:[0,0,1] op_sel_hi:[1,0,1]
  v_cvt_pk_bf16_f32 v44, v152, v153
  v_cvt_pk_bf16_f32 v45, v154, v155
  v_cvt_pk_bf16_f32 v46, v156, v157
  v_cvt_pk_bf16_f32 v47, v158, v159
  global_store_dwordx4 v17, v[44:47], s[10:11] offset:1024 sc1
  v_dot2_f32_bf16 v152, v48, s36, v10
  v_dot2_f32_bf16 v153, v48, s37, v10
  v_dot2_f32_bf16 v154, v49, s36, v10
  v_dot2_f32_bf16 v155, v49, s37, v10
  v_dot2_f32_bf16 v156, v50, s36, v10
  v_dot2_f32_bf16 v157, v50, s37, v10
  v_dot2_f32_bf16 v158, v51, s36, v10
  v_dot2_f32_bf16 v159, v51, s37, v10
  v_pk_fma_f32 v[152:153], v[152:153], v[8:9], v[8:9] op_sel:[0,0,1] op_sel_hi:[1,0,1]
  v_pk_fma_f32 v[154:155], v[154:155], v[8:9], v[8:9] op_sel:[0,0,1] op_sel_hi:[1,0,1]
  v_pk_fma_f32 v[156:157], v[156:157], v[8:9], v[8:9] op_sel:[0,0,1] op_sel_hi:[1,0,1]
  v_pk_fma_f32 v[158:159], v[158:159], v[8:9], v[8:9] op_sel:[0,0,1] op_sel_hi:[1,0,1]
  v_cvt_pk_bf16_f32 v48, v152, v153
  v_cvt_pk_bf16_f32 v49, v154, v155
  v_cvt_pk_bf16_f32 v50, v156, v157
  v_cvt_pk_bf16_f32 v51, v158, v159
  global_store_dwordx4 v17, v[48:51], s[10:11] offset:2048 sc1
  v_dot2_f32_bf16 v152, v52, s36, v10
  v_dot2_f32_bf16 v153, v52, s37, v10
  v_dot2_f32_bf16 v154, v53, s36, v10
  v_dot2_f32_bf16 v155, v53, s37, v10
  v_dot2_f32_bf16 v156, v54, s36, v10
  v_dot2_f32_bf16 v157, v54, s37, v10
  v_dot2_f32_bf16 v158, v55, s36, v10
  v_dot2_f32_bf16 v159, v55, s37, v10
  v_pk_fma_f32 v[152:153], v[152:153], v[8:9], v[8:9] op_sel:[0,0,1] op_sel_hi:[1,0,1]
  v_pk_fma_f32 v[154:155], v[154:155], v[8:9], v[8:9] op_sel:[0,0,1] op_sel_hi:[1,0,1]
  v_pk_fma_f32 v[156:157], v[156:157], v[8:9], v[8:9] op_sel:[0,0,1] op_sel_hi:[1,0,1]
  v_pk_fma_f32 v[158:159], v[158:159], v[8:9], v[8:9] op_sel:[0,0,1] op_sel_hi:[1,0,1]
  v_cvt_pk_bf16_f32 v52, v152, v153
  v_cvt_pk_bf16_f32 v53, v154, v155
  v_cvt_pk_bf16_f32 v54, v156, v157
  v_cvt_pk_bf16_f32 v55, v158, v159
  global_store_dwordx4 v17, v[52:55], s[10:11] offset:3072 sc1
  v_dot2_f32_bf16 v152, v56, s36, v10
  v_dot2_f32_bf16 v153, v56, s37, v10
  v_dot2_f32_bf16 v154, v57, s36, v10
  v_dot2_f32_bf16 v155, v57, s37, v10
  v_dot2_f32_bf16 v156, v58, s36, v10
  v_dot2_f32_bf16 v157, v58, s37, v10
  v_dot2_f32_bf16 v158, v59, s36, v10
  v_dot2_f32_bf16 v159, v59, s37, v10
  v_pk_fma_f32 v[152:153], v[152:153], v[8:9], v[8:9] op_sel:[0,0,1] op_sel_hi:[1,0,1]
  v_pk_fma_f32 v[154:155], v[154:155], v[8:9], v[8:9] op_sel:[0,0,1] op_sel_hi:[1,0,1]
  v_pk_fma_f32 v[156:157], v[156:157], v[8:9], v[8:9] op_sel:[0,0,1] op_sel_hi:[1,0,1]
  v_pk_fma_f32 v[158:159], v[158:159], v[8:9], v[8:9] op_sel:[0,0,1] op_sel_hi:[1,0,1]
  v_cvt_pk_bf16_f32 v56, v152, v153
  v_cvt_pk_bf16_f32 v57, v154, v155
  v_cvt_pk_bf16_f32 v58, v156, v157
  v_cvt_pk_bf16_f32 v59, v158, v159
  global_store_dwordx4 v18, v[56:59], s[10:11] offset:0 sc1
  v_dot2_f32_bf16 v152, v60, s36, v10
  v_dot2_f32_bf16 v153, v60, s37, v10
  v_dot2_f32_bf16 v154, v61, s36, v10
  v_dot2_f32_bf16 v155, v61, s37, v10
  v_dot2_f32_bf16 v156, v62, s36, v10
  v_dot2_f32_bf16 v157, v62, s37, v10
  v_dot2_f32_bf16 v158, v63, s36, v10
  v_dot2_f32_bf16 v159, v63, s37, v10
  v_pk_fma_f32 v[152:153], v[152:153], v[8:9], v[8:9] op_sel:[0,0,1] op_sel_hi:[1,0,1]
  v_pk_fma_f32 v[154:155], v[154:155], v[8:9], v[8:9] op_sel:[0,0,1] op_sel_hi:[1,0,1]
  v_pk_fma_f32 v[156:157], v[156:157], v[8:9], v[8:9] op_sel:[0,0,1] op_sel_hi:[1,0,1]
  v_pk_fma_f32 v[158:159], v[158:159], v[8:9], v[8:9] op_sel:[0,0,1] op_sel_hi:[1,0,1]
  v_cvt_pk_bf16_f32 v60, v152, v153
  v_cvt_pk_bf16_f32 v61, v154, v155
  v_cvt_pk_bf16_f32 v62, v156, v157
  v_cvt_pk_bf16_f32 v63, v158, v159
  global_store_dwordx4 v18, v[60:63], s[10:11] offset:1024 sc1
  v_dot2_f32_bf16 v152, v64, s36, v10
  v_dot2_f32_bf16 v153, v64, s37, v10
  v_dot2_f32_bf16 v154, v65, s36, v10
  v_dot2_f32_bf16 v155, v65, s37, v10
  v_dot2_f32_bf16 v156, v66, s36, v10
  v_dot2_f32_bf16 v157, v66, s37, v10
  v_dot2_f32_bf16 v158, v67, s36, v10
  v_dot2_f32_bf16 v159, v67, s37, v10
  v_pk_fma_f32 v[152:153], v[152:153], v[8:9], v[8:9] op_sel:[0,0,1] op_sel_hi:[1,0,1]
  v_pk_fma_f32 v[154:155], v[154:155], v[8:9], v[8:9] op_sel:[0,0,1] op_sel_hi:[1,0,1]
  v_pk_fma_f32 v[156:157], v[156:157], v[8:9], v[8:9] op_sel:[0,0,1] op_sel_hi:[1,0,1]
  v_pk_fma_f32 v[158:159], v[158:159], v[8:9], v[8:9] op_sel:[0,0,1] op_sel_hi:[1,0,1]
  v_cvt_pk_bf16_f32 v64, v152, v153
  v_cvt_pk_bf16_f32 v65, v154, v155
  v_cvt_pk_bf16_f32 v66, v156, v157
  v_cvt_pk_bf16_f32 v67, v158, v159
  global_store_dwordx4 v18, v[64:67], s[10:11] offset:2048 sc1
  v_dot2_f32_bf16 v152, v68, s36, v10
  v_dot2_f32_bf16 v153, v68, s37, v10
  v_dot2_f32_bf16 v154, v69, s36, v10
  v_dot2_f32_bf16 v155, v69, s37, v10
  v_dot2_f32_bf16 v156, v70, s36, v10
  v_dot2_f32_bf16 v157, v70, s37, v10
  v_dot2_f32_bf16 v158, v71, s36, v10
  v_dot2_f32_bf16 v159, v71, s37, v10
  v_pk_fma_f32 v[152:153], v[152:153], v[8:9], v[8:9] op_sel:[0,0,1] op_sel_hi:[1,0,1]
  v_pk_fma_f32 v[154:155], v[154:155], v[8:9], v[8:9] op_sel:[0,0,1] op_sel_hi:[1,0,1]
  v_pk_fma_f32 v[156:157], v[156:157], v[8:9], v[8:9] op_sel:[0,0,1] op_sel_hi:[1,0,1]
  v_pk_fma_f32 v[158:159], v[158:159], v[8:9], v[8:9] op_sel:[0,0,1] op_sel_hi:[1,0,1]
  v_cvt_pk_bf16_f32 v68, v152, v153
  v_cvt_pk_bf16_f32 v69, v154, v155
  v_cvt_pk_bf16_f32 v70, v156, v157
  v_cvt_pk_bf16_f32 v71, v158, v159
  global_store_dwordx4 v18, v[68:71], s[10:11] offset:3072 sc1
  v_dot2_f32_bf16 v152, v72, s36, v10
  v_dot2_f32_bf16 v153, v72, s37, v10
  v_dot2_f32_bf16 v154, v73, s36, v10
  v_dot2_f32_bf16 v155, v73, s37, v10
  v_dot2_f32_bf16 v156, v74, s36, v10
  v_dot2_f32_bf16 v157, v74, s37, v10
  v_dot2_f32_bf16 v158, v75, s36, v10
  v_dot2_f32_bf16 v159, v75, s37, v10
  v_pk_fma_f32 v[152:153], v[152:153], v[8:9], v[8:9] op_sel:[0,0,1] op_sel_hi:[1,0,1]
  v_pk_fma_f32 v[154:155], v[154:155], v[8:9], v[8:9] op_sel:[0,0,1] op_sel_hi:[1,0,1]
  v_pk_fma_f32 v[156:157], v[156:157], v[8:9], v[8:9] op_sel:[0,0,1] op_sel_hi:[1,0,1]
  v_pk_fma_f32 v[158:159], v[158:159], v[8:9], v[8:9] op_sel:[0,0,1] op_sel_hi:[1,0,1]
  v_cvt_pk_bf16_f32 v72, v152, v153
  v_cvt_pk_bf16_f32 v73, v154, v155
  v_cvt_pk_bf16_f32 v74, v156, v157
  v_cvt_pk_bf16_f32 v75, v158, v159
  global_store_dwordx4 v19, v[72:75], s[10:11] offset:0 sc1
  v_dot2_f32_bf16 v152, v76, s36, v10
  v_dot2_f32_bf16 v153, v76, s37, v10
  v_dot2_f32_bf16 v154, v77, s36, v10
  v_dot2_f32_bf16 v155, v77, s37, v10
  v_dot2_f32_bf16 v156, v78, s36, v10
  v_dot2_f32_bf16 v157, v78, s37, v10
  v_dot2_f32_bf16 v158, v79, s36, v10
  v_dot2_f32_bf16 v159, v79, s37, v10
  v_pk_fma_f32 v[152:153], v[152:153], v[8:9], v[8:9] op_sel:[0,0,1] op_sel_hi:[1,0,1]
  v_pk_fma_f32 v[154:155], v[154:155], v[8:9], v[8:9] op_sel:[0,0,1] op_sel_hi:[1,0,1]
  v_pk_fma_f32 v[156:157], v[156:157], v[8:9], v[8:9] op_sel:[0,0,1] op_sel_hi:[1,0,1]
  v_pk_fma_f32 v[158:159], v[158:159], v[8:9], v[8:9] op_sel:[0,0,1] op_sel_hi:[1,0,1]
  v_cvt_pk_bf16_f32 v76, v152, v153
  v_cvt_pk_bf16_f32 v77, v154, v155
  v_cvt_pk_bf16_f32 v78, v156, v157
  v_cvt_pk_bf16_f32 v79, v158, v159
  global_store_dwordx4 v19, v[76:79], s[10:11] offset:1024 sc1
  s_setprio 0
  v_dot2_f32_bf16 v152, v80, s36, v10
  v_dot2_f32_bf16 v153, v80, s37, v10
  v_dot2_f32_bf16 v154, v81, s36, v10
  v_dot2_f32_bf16 v155, v81, s37, v10
  v_dot2_f32_bf16 v156, v82, s36, v10
  v_dot2_f32_bf16 v157, v82, s37, v10
  v_dot2_f32_bf16 v158, v83, s36, v10
  v_dot2_f32_bf16 v159, v83, s37, v10
  v_pk_fma_f32 v[152:153], v[152:153], v[8:9], v[8:9] op_sel:[0,0,1] op_sel_hi:[1,0,1]
  v_pk_fma_f32 v[154:155], v[154:155], v[8:9], v[8:9] op_sel:[0,0,1] op_sel_hi:[1,0,1]
  v_pk_fma_f32 v[156:157], v[156:157], v[8:9], v[8:9] op_sel:[0,0,1] op_sel_hi:[1,0,1]
  v_pk_fma_f32 v[158:159], v[158:159], v[8:9], v[8:9] op_sel:[0,0,1] op_sel_hi:[1,0,1]
  v_cvt_pk_bf16_f32 v80, v152, v153
  v_cvt_pk_bf16_f32 v81, v154, v155
  v_cvt_pk_bf16_f32 v82, v156, v157
  v_cvt_pk_bf16_f32 v83, v158, v159
  global_store_dwordx4 v19, v[80:83], s[10:11] offset:2048 sc1
  v_dot2_f32_bf16 v152, v84, s36, v10
  v_dot2_f32_bf16 v153, v84, s37, v10
  v_dot2_f32_bf16 v154, v85, s36, v10
  v_dot2_f32_bf16 v155, v85, s37, v10
  v_dot2_f32_bf16 v156, v86, s36, v10
  v_dot2_f32_bf16 v157, v86, s37, v10
  v_dot2_f32_bf16 v158, v87, s36, v10
  v_dot2_f32_bf16 v159, v87, s37, v10
  v_pk_fma_f32 v[152:153], v[152:153], v[8:9], v[8:9] op_sel:[0,0,1] op_sel_hi:[1,0,1]
  v_pk_fma_f32 v[154:155], v[154:155], v[8:9], v[8:9] op_sel:[0,0,1] op_sel_hi:[1,0,1]
  v_pk_fma_f32 v[156:157], v[156:157], v[8:9], v[8:9] op_sel:[0,0,1] op_sel_hi:[1,0,1]
  v_pk_fma_f32 v[158:159], v[158:159], v[8:9], v[8:9] op_sel:[0,0,1] op_sel_hi:[1,0,1]
  v_cvt_pk_bf16_f32 v84, v152, v153
  v_cvt_pk_bf16_f32 v85, v154, v155
  v_cvt_pk_bf16_f32 v86, v156, v157
  v_cvt_pk_bf16_f32 v87, v158, v159
  global_store_dwordx4 v19, v[84:87], s[10:11] offset:3072 sc1
  v_dot2_f32_bf16 v152, v88, s36, v10
  v_dot2_f32_bf16 v153, v88, s37, v10
  v_dot2_f32_bf16 v154, v89, s36, v10
  v_dot2_f32_bf16 v155, v89, s37, v10
  v_dot2_f32_bf16 v156, v90, s36, v10
  v_dot2_f32_bf16 v157, v90, s37, v10
  v_dot2_f32_bf16 v158, v91, s36, v10
  v_dot2_f32_bf16 v159, v91, s37, v10
  v_pk_fma_f32 v[152:153], v[152:153], v[8:9], v[8:9] op_sel:[0,0,1] op_sel_hi:[1,0,1]
  v_pk_fma_f32 v[154:155], v[154:155], v[8:9], v[8:9] op_sel:[0,0,1] op_sel_hi:[1,0,1]
  v_pk_fma_f32 v[156:157], v[156:157], v[8:9], v[8:9] op_sel:[0,0,1] op_sel_hi:[1,0,1]
  v_pk_fma_f32 v[158:159], v[158:159], v[8:9], v[8:9] op_sel:[0,0,1] op_sel_hi:[1,0,1]
  v_cvt_pk_bf16_f32 v88, v152, v153
  v_cvt_pk_bf16_f32 v89, v154, v155
  v_cvt_pk_bf16_f32 v90, v156, v157
  v_cvt_pk_bf16_f32 v91, v158, v159
  global_store_dwordx4 v20, v[88:91], s[10:11] offset:0 sc1
  v_dot2_f32_bf16 v152, v92, s36, v10
  v_dot2_f32_bf16 v153, v92, s37, v10
  v_dot2_f32_bf16 v154, v93, s36, v10
  v_dot2_f32_bf16 v155, v93, s37, v10
  v_dot2_f32_bf16 v156, v94, s36, v10
  v_dot2_f32_bf16 v157, v94, s37, v10
  v_dot2_f32_bf16 v158, v95, s36, v10
  v_dot2_f32_bf16 v159, v95, s37, v10
  v_pk_fma_f32 v[152:153], v[152:153], v[8:9], v[8:9] op_sel:[0,0,1] op_sel_hi:[1,0,1]
  v_pk_fma_f32 v[154:155], v[154:155], v[8:9], v[8:9] op_sel:[0,0,1] op_sel_hi:[1,0,1]
  v_pk_fma_f32 v[156:157], v[156:157], v[8:9], v[8:9] op_sel:[0,0,1] op_sel_hi:[1,0,1]
  v_pk_fma_f32 v[158:159], v[158:159], v[8:9], v[8:9] op_sel:[0,0,1] op_sel_hi:[1,0,1]
  v_cvt_pk_bf16_f32 v92, v152, v153
  v_cvt_pk_bf16_f32 v93, v154, v155
  v_cvt_pk_bf16_f32 v94, v156, v157
  v_cvt_pk_bf16_f32 v95, v158, v159
  global_store_dwordx4 v20, v[92:95], s[10:11] offset:1024 sc1
  v_dot2_f32_bf16 v152, v96, s36, v10
  v_dot2_f32_bf16 v153, v96, s37, v10
  v_dot2_f32_bf16 v154, v97, s36, v10
  v_dot2_f32_bf16 v155, v97, s37, v10
  v_dot2_f32_bf16 v156, v98, s36, v10
  v_dot2_f32_bf16 v157, v98, s37, v10
  v_dot2_f32_bf16 v158, v99, s36, v10
  v_dot2_f32_bf16 v159, v99, s37, v10
  v_pk_fma_f32 v[152:153], v[152:153], v[8:9], v[8:9] op_sel:[0,0,1] op_sel_hi:[1,0,1]
  v_pk_fma_f32 v[154:155], v[154:155], v[8:9], v[8:9] op_sel:[0,0,1] op_sel_hi:[1,0,1]
  v_pk_fma_f32 v[156:157], v[156:157], v[8:9], v[8:9] op_sel:[0,0,1] op_sel_hi:[1,0,1]
  v_pk_fma_f32 v[158:159], v[158:159], v[8:9], v[8:9] op_sel:[0,0,1] op_sel_hi:[1,0,1]
  v_cvt_pk_bf16_f32 v96, v152, v153
  v_cvt_pk_bf16_f32 v97, v154, v155
  v_cvt_pk_bf16_f32 v98, v156, v157
  v_cvt_pk_bf16_f32 v99, v158, v159
  global_store_dwordx4 v20, v[96:99], s[10:11] offset:2048 sc1
  v_dot2_f32_bf16 v152, v100, s36, v10
  v_dot2_f32_bf16 v153, v100, s37, v10
  v_dot2_f32_bf16 v154, v101, s36, v10
  v_dot2_f32_bf16 v155, v101, s37, v10
  v_dot2_f32_bf16 v156, v102, s36, v10
  v_dot2_f32_bf16 v157, v102, s37, v10
  v_dot2_f32_bf16 v158, v103, s36, v10
  v_dot2_f32_bf16 v159, v103, s37, v10
  v_pk_fma_f32 v[152:153], v[152:153], v[8:9], v[8:9] op_sel:[0,0,1] op_sel_hi:[1,0,1]
  v_pk_fma_f32 v[154:155], v[154:155], v[8:9], v[8:9] op_sel:[0,0,1] op_sel_hi:[1,0,1]
  v_pk_fma_f32 v[156:157], v[156:157], v[8:9], v[8:9] op_sel:[0,0,1] op_sel_hi:[1,0,1]
  v_pk_fma_f32 v[158:159], v[158:159], v[8:9], v[8:9] op_sel:[0,0,1] op_sel_hi:[1,0,1]
  v_cvt_pk_bf16_f32 v100, v152, v153
  v_cvt_pk_bf16_f32 v101, v154, v155
  v_cvt_pk_bf16_f32 v102, v156, v157
  v_cvt_pk_bf16_f32 v103, v158, v159
  global_store_dwordx4 v20, v[100:103], s[10:11] offset:3072 sc1
  v_dot2_f32_bf16 v152, v104, s36, v10
  v_dot2_f32_bf16 v153, v104, s37, v10
  v_dot2_f32_bf16 v154, v105, s36, v10
  v_dot2_f32_bf16 v155, v105, s37, v10
  v_dot2_f32_bf16 v156, v106, s36, v10
  v_dot2_f32_bf16 v157, v106, s37, v10
  v_dot2_f32_bf16 v158, v107, s36, v10
  v_dot2_f32_bf16 v159, v107, s37, v10
  v_pk_fma_f32 v[152:153], v[152:153], v[8:9], v[8:9] op_sel:[0,0,1] op_sel_hi:[1,0,1]
  v_pk_fma_f32 v[154:155], v[154:155], v[8:9], v[8:9] op_sel:[0,0,1] op_sel_hi:[1,0,1]
  v_pk_fma_f32 v[156:157], v[156:157], v[8:9], v[8:9] op_sel:[0,0,1] op_sel_hi:[1,0,1]
  v_pk_fma_f32 v[158:159], v[158:159], v[8:9], v[8:9] op_sel:[0,0,1] op_sel_hi:[1,0,1]
  v_cvt_pk_bf16_f32 v104, v152, v153
  v_cvt_pk_bf16_f32 v105, v154, v155
  v_cvt_pk_bf16_f32 v106, v156, v157
  v_cvt_pk_bf16_f32 v107, v158, v159
  global_store_dwordx4 v21, v[104:107], s[10:11] offset:0 sc1
  v_dot2_f32_bf16 v152, v108, s36, v10
  v_dot2_f32_bf16 v153, v108, s37, v10
  v_dot2_f32_bf16 v154, v109, s36, v10
  v_dot2_f32_bf16 v155, v109, s37, v10
  v_dot2_f32_bf16 v156, v110, s36, v10
  v_dot2_f32_bf16 v157, v110, s37, v10
  v_dot2_f32_bf16 v158, v111, s36, v10
  v_dot2_f32_bf16 v159, v111, s37, v10
  v_pk_fma_f32 v[152:153], v[152:153], v[8:9], v[8:9] op_sel:[0,0,1] op_sel_hi:[1,0,1]
  v_pk_fma_f32 v[154:155], v[154:155], v[8:9], v[8:9] op_sel:[0,0,1] op_sel_hi:[1,0,1]
  v_pk_fma_f32 v[156:157], v[156:157], v[8:9], v[8:9] op_sel:[0,0,1] op_sel_hi:[1,0,1]
  v_pk_fma_f32 v[158:159], v[158:159], v[8:9], v[8:9] op_sel:[0,0,1] op_sel_hi:[1,0,1]
  v_cvt_pk_bf16_f32 v108, v152, v153
  v_cvt_pk_bf16_f32 v109, v154, v155
  v_cvt_pk_bf16_f32 v110, v156, v157
  v_cvt_pk_bf16_f32 v111, v158, v159
  global_store_dwordx4 v21, v[108:111], s[10:11] offset:1024 sc1
  v_dot2_f32_bf16 v152, v112, s36, v10
  v_dot2_f32_bf16 v153, v112, s37, v10
  v_dot2_f32_bf16 v154, v113, s36, v10
  v_dot2_f32_bf16 v155, v113, s37, v10
  v_dot2_f32_bf16 v156, v114, s36, v10
  v_dot2_f32_bf16 v157, v114, s37, v10
  v_dot2_f32_bf16 v158, v115, s36, v10
  v_dot2_f32_bf16 v159, v115, s37, v10
  v_pk_fma_f32 v[152:153], v[152:153], v[8:9], v[8:9] op_sel:[0,0,1] op_sel_hi:[1,0,1]
  v_pk_fma_f32 v[154:155], v[154:155], v[8:9], v[8:9] op_sel:[0,0,1] op_sel_hi:[1,0,1]
  v_pk_fma_f32 v[156:157], v[156:157], v[8:9], v[8:9] op_sel:[0,0,1] op_sel_hi:[1,0,1]
  v_pk_fma_f32 v[158:159], v[158:159], v[8:9], v[8:9] op_sel:[0,0,1] op_sel_hi:[1,0,1]
  v_cvt_pk_bf16_f32 v112, v152, v153
  v_cvt_pk_bf16_f32 v113, v154, v155
  v_cvt_pk_bf16_f32 v114, v156, v157
  v_cvt_pk_bf16_f32 v115, v158, v159
  global_store_dwordx4 v21, v[112:115], s[10:11] offset:2048 sc1
  v_dot2_f32_bf16 v152, v116, s36, v10
  v_dot2_f32_bf16 v153, v116, s37, v10
  v_dot2_f32_bf16 v154, v117, s36, v10
  v_dot2_f32_bf16 v155, v117, s37, v10
  v_dot2_f32_bf16 v156, v118, s36, v10
  v_dot2_f32_bf16 v157, v118, s37, v10
  v_dot2_f32_bf16 v158, v119, s36, v10
  v_dot2_f32_bf16 v159, v119, s37, v10
  v_pk_fma_f32 v[152:153], v[152:153], v[8:9], v[8:9] op_sel:[0,0,1] op_sel_hi:[1,0,1]
  v_pk_fma_f32 v[154:155], v[154:155], v[8:9], v[8:9] op_sel:[0,0,1] op_sel_hi:[1,0,1]
  v_pk_fma_f32 v[156:157], v[156:157], v[8:9], v[8:9] op_sel:[0,0,1] op_sel_hi:[1,0,1]
  v_pk_fma_f32 v[158:159], v[158:159], v[8:9], v[8:9] op_sel:[0,0,1] op_sel_hi:[1,0,1]
  v_cvt_pk_bf16_f32 v116, v152, v153
  v_cvt_pk_bf16_f32 v117, v154, v155
  v_cvt_pk_bf16_f32 v118, v156, v157
  v_cvt_pk_bf16_f32 v119, v158, v159
  global_store_dwordx4 v21, v[116:119], s[10:11] offset:3072 sc1
  v_dot2_f32_bf16 v152, v120, s36, v10
  v_dot2_f32_bf16 v153, v120, s37, v10
  v_dot2_f32_bf16 v154, v121, s36, v10
  v_dot2_f32_bf16 v155, v121, s37, v10
  v_dot2_f32_bf16 v156, v122, s36, v10
  v_dot2_f32_bf16 v157, v122, s37, v10
  v_dot2_f32_bf16 v158, v123, s36, v10
  v_dot2_f32_bf16 v159, v123, s37, v10
  v_pk_fma_f32 v[152:153], v[152:153], v[8:9], v[8:9] op_sel:[0,0,1] op_sel_hi:[1,0,1]
  v_pk_fma_f32 v[154:155], v[154:155], v[8:9], v[8:9] op_sel:[0,0,1] op_sel_hi:[1,0,1]
  v_pk_fma_f32 v[156:157], v[156:157], v[8:9], v[8:9] op_sel:[0,0,1] op_sel_hi:[1,0,1]
  v_pk_fma_f32 v[158:159], v[158:159], v[8:9], v[8:9] op_sel:[0,0,1] op_sel_hi:[1,0,1]
  v_cvt_pk_bf16_f32 v120, v152, v153
  v_cvt_pk_bf16_f32 v121, v154, v155
  v_cvt_pk_bf16_f32 v122, v156, v157
  v_cvt_pk_bf16_f32 v123, v158, v159
  global_store_dwordx4 v22, v[120:123], s[10:11] offset:0 sc1
  v_dot2_f32_bf16 v152, v124, s36, v10
  v_dot2_f32_bf16 v153, v124, s37, v10
  v_dot2_f32_bf16 v154, v125, s36, v10
  v_dot2_f32_bf16 v155, v125, s37, v10
  v_dot2_f32_bf16 v156, v126, s36, v10
  v_dot2_f32_bf16 v157, v126, s37, v10
  v_dot2_f32_bf16 v158, v127, s36, v10
  v_dot2_f32_bf16 v159, v127, s37, v10
  v_pk_fma_f32 v[152:153], v[152:153], v[8:9], v[8:9] op_sel:[0,0,1] op_sel_hi:[1,0,1]
  v_pk_fma_f32 v[154:155], v[154:155], v[8:9], v[8:9] op_sel:[0,0,1] op_sel_hi:[1,0,1]
  v_pk_fma_f32 v[156:157], v[156:157], v[8:9], v[8:9] op_sel:[0,0,1] op_sel_hi:[1,0,1]
  v_pk_fma_f32 v[158:159], v[158:159], v[8:9], v[8:9] op_sel:[0,0,1] op_sel_hi:[1,0,1]
  v_cvt_pk_bf16_f32 v124, v152, v153
  v_cvt_pk_bf16_f32 v125, v154, v155
  v_cvt_pk_bf16_f32 v126, v156, v157
  v_cvt_pk_bf16_f32 v127, v158, v159
  global_store_dwordx4 v22, v[124:127], s[10:11] offset:1024 sc1
  v_dot2_f32_bf16 v152, v128, s36, v10
  v_dot2_f32_bf16 v153, v128, s37, v10
  v_dot2_f32_bf16 v154, v129, s36, v10
  v_dot2_f32_bf16 v155, v129, s37, v10
  v_dot2_f32_bf16 v156, v130, s36, v10
  v_dot2_f32_bf16 v157, v130, s37, v10
  v_dot2_f32_bf16 v158, v131, s36, v10
  v_dot2_f32_bf16 v159, v131, s37, v10
  v_pk_fma_f32 v[152:153], v[152:153], v[8:9], v[8:9] op_sel:[0,0,1] op_sel_hi:[1,0,1]
  v_pk_fma_f32 v[154:155], v[154:155], v[8:9], v[8:9] op_sel:[0,0,1] op_sel_hi:[1,0,1]
  v_pk_fma_f32 v[156:157], v[156:157], v[8:9], v[8:9] op_sel:[0,0,1] op_sel_hi:[1,0,1]
  v_pk_fma_f32 v[158:159], v[158:159], v[8:9], v[8:9] op_sel:[0,0,1] op_sel_hi:[1,0,1]
  v_cvt_pk_bf16_f32 v128, v152, v153
  v_cvt_pk_bf16_f32 v129, v154, v155
  v_cvt_pk_bf16_f32 v130, v156, v157
  v_cvt_pk_bf16_f32 v131, v158, v159
  global_store_dwordx4 v22, v[128:131], s[10:11] offset:2048 sc1
  v_dot2_f32_bf16 v152, v132, s36, v10
  v_dot2_f32_bf16 v153, v132, s37, v10
  v_dot2_f32_bf16 v154, v133, s36, v10
  v_dot2_f32_bf16 v155, v133, s37, v10
  v_dot2_f32_bf16 v156, v134, s36, v10
  v_dot2_f32_bf16 v157, v134, s37, v10
  v_dot2_f32_bf16 v158, v135, s36, v10
  v_dot2_f32_bf16 v159, v135, s37, v10
  v_pk_fma_f32 v[152:153], v[152:153], v[8:9], v[8:9] op_sel:[0,0,1] op_sel_hi:[1,0,1]
  v_pk_fma_f32 v[154:155], v[154:155], v[8:9], v[8:9] op_sel:[0,0,1] op_sel_hi:[1,0,1]
  v_pk_fma_f32 v[156:157], v[156:157], v[8:9], v[8:9] op_sel:[0,0,1] op_sel_hi:[1,0,1]
  v_pk_fma_f32 v[158:159], v[158:159], v[8:9], v[8:9] op_sel:[0,0,1] op_sel_hi:[1,0,1]
  v_cvt_pk_bf16_f32 v132, v152, v153
  v_cvt_pk_bf16_f32 v133, v154, v155
  v_cvt_pk_bf16_f32 v134, v156, v157
  v_cvt_pk_bf16_f32 v135, v158, v159
  global_store_dwordx4 v22, v[132:135], s[10:11] offset:3072 sc1
  v_dot2_f32_bf16 v152, v136, s36, v10
  v_dot2_f32_bf16 v153, v136, s37, v10
  v_dot2_f32_bf16 v154, v137, s36, v10
  v_dot2_f32_bf16 v155, v137, s37, v10
  v_dot2_f32_bf16 v156, v138, s36, v10
  v_dot2_f32_bf16 v157, v138, s37, v10
  v_dot2_f32_bf16 v158, v139, s36, v10
  v_dot2_f32_bf16 v159, v139, s37, v10
  v_pk_fma_f32 v[152:153], v[152:153], v[8:9], v[8:9] op_sel:[0,0,1] op_sel_hi:[1,0,1]
  v_pk_fma_f32 v[154:155], v[154:155], v[8:9], v[8:9] op_sel:[0,0,1] op_sel_hi:[1,0,1]
  v_pk_fma_f32 v[156:157], v[156:157], v[8:9], v[8:9] op_sel:[0,0,1] op_sel_hi:[1,0,1]
  v_pk_fma_f32 v[158:159], v[158:159], v[8:9], v[8:9] op_sel:[0,0,1] op_sel_hi:[1,0,1]
  v_cvt_pk_bf16_f32 v136, v152, v153
  v_cvt_pk_bf16_f32 v137, v154, v155
  v_cvt_pk_bf16_f32 v138, v156, v157
  v_cvt_pk_bf16_f32 v139, v158, v159
  global_store_dwordx4 v23, v[136:139], s[10:11] offset:0 sc1
  v_dot2_f32_bf16 v152, v140, s36, v10
  v_dot2_f32_bf16 v153, v140, s37, v10
  v_dot2_f32_bf16 v154, v141, s36, v10
  v_dot2_f32_bf16 v155, v141, s37, v10
  v_dot2_f32_bf16 v156, v142, s36, v10
  v_dot2_f32_bf16 v157, v142, s37, v10
  v_dot2_f32_bf16 v158, v143, s36, v10
  v_dot2_f32_bf16 v159, v143, s37, v10
  v_pk_fma_f32 v[152:153], v[152:153], v[8:9], v[8:9] op_sel:[0,0,1] op_sel_hi:[1,0,1]
  v_pk_fma_f32 v[154:155], v[154:155], v[8:9], v[8:9] op_sel:[0,0,1] op_sel_hi:[1,0,1]
  v_pk_fma_f32 v[156:157], v[156:157], v[8:9], v[8:9] op_sel:[0,0,1] op_sel_hi:[1,0,1]
  v_pk_fma_f32 v[158:159], v[158:159], v[8:9], v[8:9] op_sel:[0,0,1] op_sel_hi:[1,0,1]
  v_cvt_pk_bf16_f32 v140, v152, v153
  v_cvt_pk_bf16_f32 v141, v154, v155
  v_cvt_pk_bf16_f32 v142, v156, v157
  v_cvt_pk_bf16_f32 v143, v158, v159
  global_store_dwordx4 v23, v[140:143], s[10:11] offset:1024 sc1
  v_dot2_f32_bf16 v152, v144, s36, v10
  v_dot2_f32_bf16 v153, v144, s37, v10
  v_dot2_f32_bf16 v154, v145, s36, v10
  v_dot2_f32_bf16 v155, v145, s37, v10
  v_dot2_f32_bf16 v156, v146, s36, v10
  v_dot2_f32_bf16 v157, v146, s37, v10
  v_dot2_f32_bf16 v158, v147, s36, v10
  v_dot2_f32_bf16 v159, v147, s37, v10
  v_pk_fma_f32 v[152:153], v[152:153], v[8:9], v[8:9] op_sel:[0,0,1] op_sel_hi:[1,0,1]
  v_pk_fma_f32 v[154:155], v[154:155], v[8:9], v[8:9] op_sel:[0,0,1] op_sel_hi:[1,0,1]
  v_pk_fma_f32 v[156:157], v[156:157], v[8:9], v[8:9] op_sel:[0,0,1] op_sel_hi:[1,0,1]
  v_pk_fma_f32 v[158:159], v[158:159], v[8:9], v[8:9] op_sel:[0,0,1] op_sel_hi:[1,0,1]
  v_cvt_pk_bf16_f32 v144, v152, v153
  v_cvt_pk_bf16_f32 v145, v154, v155
  v_cvt_pk_bf16_f32 v146, v156, v157
  v_cvt_pk_bf16_f32 v147, v158, v159
  global_store_dwordx4 v23, v[144:147], s[10:11] offset:2048 sc1
  v_dot2_f32_bf16 v152, v148, s36, v10
  v_dot2_f32_bf16 v153, v148, s37, v10
  v_dot2_f32_bf16 v154, v149, s36, v10
  v_dot2_f32_bf16 v155, v149, s37, v10
  v_dot2_f32_bf16 v156, v150, s36, v10
  v_dot2_f32_bf16 v157, v150, s37, v10
  v_dot2_f32_bf16 v158, v151, s36, v10
  v_dot2_f32_bf16 v159, v151, s37, v10
  v_pk_fma_f32 v[152:153], v[152:153], v[8:9], v[8:9] op_sel:[0,0,1] op_sel_hi:[1,0,1]
  v_pk_fma_f32 v[154:155], v[154:155], v[8:9], v[8:9] op_sel:[0,0,1] op_sel_hi:[1,0,1]
  v_pk_fma_f32 v[156:157], v[156:157], v[8:9], v[8:9] op_sel:[0,0,1] op_sel_hi:[1,0,1]
  v_pk_fma_f32 v[158:159], v[158:159], v[8:9], v[8:9] op_sel:[0,0,1] op_sel_hi:[1,0,1]
  v_cvt_pk_bf16_f32 v148, v152, v153
  v_cvt_pk_bf16_f32 v149, v154, v155
  v_cvt_pk_bf16_f32 v150, v156, v157
  v_cvt_pk_bf16_f32 v151, v158, v159
  global_store_dwordx4 v23, v[148:151], s[10:11] offset:3072 sc1
  s_cmp_eq_u32 s33, 2
  s_cbranch_scc0 L_done
  s_waitcnt vmcnt(0)
L_switch:
  s_add_u32 s33, s33, 1
  s_xor_b32 s26, s26, 1
  s_branch L_saddr
L_split:
  s_lshr_b32 s17, s16, 1
  s_lshl_b32 s18, s17, 2
  s_lshl_b32 s19, s17, 4
  v_mov_b32 v11, s18
  v_mov_b32 v12, 1
  v_mov_b32 v15, s19
  ds_add_rtn_u32 v12, v11, v12 offset:64
  v_xor_b32 v10, 8, v10
  s_waitcnt lgkmcnt(0)
  v_readlane_b32 s36, v12, 63
  s_bitcmp1_b32 s36, 0
  s_cbranch_scc0 L_pwait
  ds_read_b64 v[12:13], v10
  v_mov_b32 v8, v6
  s_lshl_b32 s27, s17, 4
  s_xor_b32 s27, s27, 16
  s_lshl_b32 s35, s29, s27
  s_lshl_b32 s27, s30, s27
  s_and_b32 s35, s35, s31
  s_and_b32 s27, s27, s31
  s_lshl_b32 s36, s22, 6
  s_add_u32 s36, s36, 0x80000
  s_add_u32 s38, s14, s36
  s_addc_u32 s39, s15, 0
  s_lshl_b32 s56, s25, 5
  s_add_u32 s56, s56, s19
  s_add_u32 s57, s56, 8
  s_xor_b32 s46, s56, 32
  s_andn2_b32 s45, s44, 0xff
  s_mov_b32 s53, s45
  s_mov_b32 s55, s45
  s_waitcnt lgkmcnt(0)
  v_sub_f32 v14, v12, v8
  v_add_f32 v8, v12, v8
  v_add_f32 v7, v13, v7
  v_mul_f32 v8, 0.5, v8
  v_mul_f32 v14, v14, v14
  v_fmac_f32 v7, 0x46000000, v14
  s_cmp_eq_u32 s33, 1
  s_cbranch_scc0 L_alone
  v_readlane_b32 s52, v8, 63
  v_readlane_b32 s54, v7, 63
  s_bitcmp1_b32 s44, 2
  s_cbranch_scc1 L_timeout
  s_mov_b32 s34, 0
  s_nop 1
  s_atomic_swap_x2 s[52:53], s[38:39], s56
  s_atomic_swap_x2 s[54:55], s[38:39], s57
L_poll:
  s_load_dwordx4 s[40:43], s[38:39], s46 glc
  s_add_u32 s34, s34, 1
  s_waitcnt lgkmcnt(0)
  s_xor_b32 s41, s41, s45
  s_xor_b32 s43, s43, s45
  s_or_b32 s41, s41, s43
  s_cbranch_scc0 L_got
  s_cmp_lt_u32 s34, 4096
  s_cbranch_scc1 L_poll
L_timeout:
  v_mov_b32 v9, v7
  ds_write_b64 v15, v[8:9] offset:160
  v_mov_b32 v11, 5
  s_branch L_flag
L_alone:
  v_mov_b32 v11, 12
  s_cmp_eq_u32 s33, 3
  s_cbranch_scc1 L_flag
  ds_read_b64 v[12:13], v15 offset:160
  s_waitcnt lgkmcnt(0)
  s_branch L_comb
L_got:
  v_mov_b32 v12, s40
  v_mov_b32 v13, s42
L_comb:
  v_sub_f32 v14, v12, v8
  v_add_f32 v8, v12, v8
  v_add_f32 v7, v13, v7
  v_mul_f32 v8, 0.5, v8
  v_mul_f32 v14, v14, v14
  v_fmac_f32 v7, 0x46800000, v14
  v_cvt_pk_bf16_f32 v10, v8, v8
  v_and_b32 v10, s31, v10
  v_sub_f32 v8, v8, v10
  v_mul_f32 v8, v8, v8
  v_fmac_f32 v8, 0x37800000, v7
  v_max_f32 v8, 0, v8
  v_cvt_pk_bf16_f32 v8, v8, v8
  v_and_b32 v8, s31, v8
  v_add_f32 v8, 0x3727c5ac, v8
  v_cvt_pk_bf16_f32 v8, v8, v8
  v_and_b32 v8, s31, v8
  v_sqrt_f32 v8, v8
  v_mov_b32 v9, s27
  v_cvt_pk_bf16_f32 v8, v8, v8
  v_and_b32 v8, s31, v8
  v_rcp_f32 v8, v8
  s_nop 0
  v_mul_f32 v8, s35, v8
  s_lshl_b32 s36, s33, 2
  v_mov_b32 v11, s36
  ds_write_b96 v15, v[8:10] offset:128
L_flag:
  ds_write_b32 v15, v11 offset:140
L_pwait:
  s_mov_b64 exec, -1
  v_mov_b32 v15, s19
L_pspin:
  ds_read_b128 v[8:11], v15 offset:128
  s_waitcnt lgkmcnt(0)
  v_readfirstlane_b32 s36, v11
  s_lshr_b32 s37, s36, 2
  s_cmp_lg_u32 s37, s33
  s_cbranch_scc1 L_pspin
  s_bitcmp1_b32 s36, 0
  s_cbranch_scc1 L_switch
  s_branch L_norm
L_done:
L_end:
  s_endpgm
.section .rodata,"a"
.p2align 6
.amdhsa_kernel standalone__instancenorm__prompt_kernel
  .amdhsa_next_free_vgpr 160
  .amdhsa_next_free_sgpr 60
  .amdhsa_accum_offset 160
  .amdhsa_group_segment_fixed_size 0
  .amdhsa_kernarg_size 48
  .amdhsa_user_sgpr_count 2
  .amdhsa_user_sgpr_kernarg_segment_ptr 1
  .amdhsa_system_sgpr_workgroup_id_x 1
  .amdhsa_float_denorm_mode_32 3
.end_amdhsa_kernel
```
